```python
import torch

def _softmax(x, axis=-1):
    return torch.softmax(x, dim=axis)
def _gelu(x):
    return torch.nn.functional.gelu(x, approximate="tanh")
def _silu(x):
    return torch.nn.functional.silu(x)
def _sigmoid(x):
    return torch.sigmoid(x)
def _layernorm(x, axis=-1, eps=1e-5):
    m = x.mean(dim=axis, keepdim=True)
    v = x.var(dim=axis, keepdim=True, unbiased=False)
    return (x - m) / torch.sqrt(v + eps)
def _scatter_add(tgt, idx, src, axis=0):
    return tgt.clone().index_add_(axis, idx, src)
def _segment_sum(src, seg, n):
    out = torch.zeros((n,) + src.shape[1:], dtype=src.dtype)
    return out.index_add_(0, seg, src)
def _pad(x, pw):
    flat = tuple(v for pair in reversed(pw) for v in pair)
    return torch.nn.functional.pad(x, flat)

kernel_name = 'concat_heads__softmax_full_mha__sliding_block__prompt'

def setup_inputs():

    _w = (lambda a: (lambda t: t.to(torch.bfloat16) if t.is_floating_point() else t)(torch.as_tensor(a)))
    def _A_setup():
        B, S, D = 1, 2048, 640
        return {
            "x": _w((lambda *s: torch.randn(*s, dtype=torch.bfloat16) * 0.2)(B, S, D)),
            "wqkv": _w((lambda *s: torch.randn(*s, dtype=torch.bfloat16) * 0.4)(D, 3 * D)),
            "wo": _w((lambda *s: torch.randn(*s, dtype=torch.bfloat16) * 0.1)(D, D)),
        }
    _A_in = _A_setup()

    def _B_setup():
        B, S, D = 1, 2048, 640
        return {
            "x": _w((lambda *s: torch.randn(*s, dtype=torch.bfloat16) * 0.4)(B, S, D)),
            "wqkv": _w((lambda *s: torch.randn(*s, dtype=torch.bfloat16) * 0.4)(D, 3 * D)),
            "wo": _w((lambda *s: torch.randn(*s, dtype=torch.bfloat16) * 0.05)(D, D)),
        }
    _B_in = _B_setup()

    return {
        "A_x": _A_in["x"],
        "A_wqkv": _A_in["wqkv"],
        "A_wo": _A_in["wo"],
        "B_x": _B_in["x"],
        "B_wqkv": _B_in["wqkv"],
        "B_wo": _B_in["wo"],
    }

def reference(A_x, A_wqkv, A_wo, B_x, B_wqkv, B_wo):
    def _A_ref(x, wqkv, wo):
        B, S, D = x.shape
        H = 32; Dh = D // H
        qkv = (lambda x, *d: x.permute(*d))((x @ wqkv).reshape(B, S, 3, H, Dh), 2, 0, 3, 1, 4)
        q, k, v = qkv[0], qkv[1], qkv[2]
        scale = Dh ** -0.5
        scores = torch.einsum("bhqd,bhkd->bhqk", q, k) * scale
        p = _softmax(scores, axis=-1)
        o = torch.einsum("bhqk,bhkd->bhqd", p, v)
        return (lambda x, *d: x.permute(*d))(o, 0, 2, 1, 3).reshape(B, S, D) @ wo

    def _B_ref(x, wqkv, wo):
        B, S, D = x.shape
        H = 32; Dh = D // H; W = 256
        qkv = (lambda x, *d: x.permute(*d))((x @ wqkv).reshape(B, S, 3, H, Dh), 2, 0, 3, 1, 4)
        q, k, v = qkv[0], qkv[1], qkv[2]
        scores = torch.einsum("bhqd,bhkd->bhqk", q, k) * (Dh ** -0.5)
        idx = torch.arange(S)
        mask = (idx[:, None] - idx[None, :] >= 0) & (idx[:, None] - idx[None, :] < W)
        scores = torch.where(mask[None, None], scores, -1e9)
        p = _softmax(scores, axis=-1)
        o = torch.einsum("bhqk,bhkd->bhqd", p, v)
        return (lambda x, *d: x.permute(*d))(o, 0, 2, 1, 3).reshape(B, S, D) @ wo

    a = _A_ref(A_x, A_wqkv, A_wo)
    b = _B_ref(B_x, B_wqkv, B_wo)
    return torch.concatenate([a, b], axis=-1)
```

```asm
; @launch grid=(256,1,1) block=(512,1,1) lds=163840
.amdgcn_target "amdgcn-amd-amdhsa--gfx950"
.text
.globl concat_heads__softmax_full_mha__sliding_block__prompt_kernel
.p2align 8
.type concat_heads__softmax_full_mha__sliding_block__prompt_kernel,@function
concat_heads__softmax_full_mha__sliding_block__prompt_kernel:
L_cbeg:
    s_cmp_ge_u32 s2, 256
    s_cbranch_scc1 L_exit
    s_load_dwordx16 s[4:19], s[0:1], 0
    s_load_dwordx2 s[20:21], s[0:1], 64
    v_lshrrev_b32 v1, 6, v0
    s_and_b32 s41, s2, 7
    v_readfirstlane_b32 s40, v1
    v_and_b32 v0, 63, v0
    s_lshr_b32 s42, s2, 3
    s_lshl3_add_u32 s48, s42, s40
    s_cmp_ge_u32 s48, 4
    s_cbranch_scc1 L_nocw
    s_getpc_b64 s[78:79]
L_cwpc:
    s_sub_u32 s78, s78, L_cwpc-L_cbeg
    s_subb_u32 s79, s79, 0
    s_lshl_b32 s48, s40, 13
    v_lshl_add_u32 v254, v0, 7, s48
    v_min_u32 v254, L_cend-L_cbeg-4, v254
    global_load_dword v255, v254, s[78:79]
L_nocw:
    s_and_b32 s48, s41, 1
    s_mul_i32 s48, s48, 30
    s_add_u32 s48, s48, s42
    s_lshr_b32 s43, s48, 2
    s_and_b32 s48, s48, 3
    s_lshr_b32 s44, s41, 1
    s_lshl2_add_u32 s44, s44, s48
    s_and_b32 s48, s42, 3
    s_lshl2_add_u32 s45, s41, s48
    s_lshr_b32 s46, s42, 2
    s_mul_i32 s63, s45, 163840
    s_mov_b32 s47, 26214400
    s_cmp_ge_u32 s42, 30
    s_cbranch_scc1 L_wt
    s_cmp_ge_u32 s40, 4
    s_cbranch_scc0 L_comp
L_loader:
    s_sub_u32 s50, s40, 4
    s_lshl_b32 s55, s50, 10
    s_add_u32 s55, s55, 98304
    v_lshrrev_b32 v5, 3, v0
    s_lshl_b32 s48, s50, 3
    v_add_u32 v5, s48, v5
    v_lshrrev_b32 v6, 1, v5
    v_xor_b32 v6, v6, v0
    v_and_b32 v6, 7, v6
    v_lshlrev_b32 v6, 4, v6
    v_mov_b32 v7, 1280
    v_mad_u32_u24 v2, v5, v7, v6
    v_lshrrev_b32 v5, 4, v0
    v_lshlrev_b32 v6, 2, v5
    v_xor_b32 v6, v6, v0
    v_and_b32 v6, 15, v6
    v_lshlrev_b32 v6, 4, v6
    s_lshl_b32 s48, s50, 2
    v_add_u32 v5, s48, v5
    v_mov_b32 v7, 3840
    v_mad_u32_u24 v3, v5, v7, v6
    s_mul_i32 s75, s44, 163840
    s_lshl_b32 s76, s43, 8
    s_mul_i32 s48, s43, 1
    s_and_b32 s49, s44, 3
    s_lshl_b32 s49, s49, 2
    s_lshr_b32 s49, 25632, s49
    s_and_b32 s49, s49, 15
    s_add_u32 s48, s48, s49
    s_mul_i32 s49, s48, 513
    s_lshr_b32 s49, s49, 12
    s_mul_i32 s49, s49, 8
    s_sub_u32 s73, s48, s49
    s_add_u32 s73, s73, 2
    s_mul_i32 s48, s43, 1
    s_and_b32 s49, s44, 3
    s_lshl_b32 s49, s49, 2
    s_lshr_b32 s49, 29984, s49
    s_and_b32 s49, s49, 15
    s_add_u32 s48, s48, s49
    s_and_b32 s49, s44, 12
    s_lshr_b32 s49, 16912, s49
    s_and_b32 s49, s49, 15
    s_add_u32 s48, s48, s49
    s_mul_i32 s49, s48, 410
    s_lshr_b32 s49, s49, 12
    s_mul_i32 s49, s49, 10
    s_sub_u32 s59, s48, s49
    s_mov_b32 s58, 2
    s_mov_b32 s74, 0
    s_mov_b32 s56, s75
    s_mov_b32 s57, s76
    s_mov_b32 s54, 0
    s_waitcnt lgkmcnt(0)
    s_mov_b32 s24, s4
    s_and_b32 s25, s5, 0xffff
    s_mov_b32 s26, 2621440
    s_mov_b32 s27, 0x00020000
    s_mov_b32 s28, s6
    s_and_b32 s29, s7, 0xffff
    s_mov_b32 s30, 2457600
    s_mov_b32 s31, 0x00020000
L_ld_loop:
    s_cmp_lt_u32 s54, 2
    s_cbranch_scc1 L_ld_nb
    s_waitcnt vmcnt(8)
    s_barrier
L_ld_nb:
    s_add_u32 m0, s55, 0
    s_add_u32 s48, s56, 0
    buffer_load_dwordx4 v2, s[24:27], s48 offen lds
    s_add_u32 m0, s55, 16384
    s_add_u32 s49, s57, 0
    buffer_load_dwordx4 v3, s[28:31], s49 offen lds
    s_add_u32 m0, s55, 4096
    s_add_u32 s48, s56, 40960
    buffer_load_dwordx4 v2, s[24:27], s48 offen lds
    s_add_u32 m0, s55, 20480
    s_add_u32 s49, s57, 61440
    buffer_load_dwordx4 v3, s[28:31], s49 offen lds
    s_add_u32 m0, s55, 8192
    s_add_u32 s48, s56, 81920
    buffer_load_dwordx4 v2, s[24:27], s48 offen lds
    s_add_u32 m0, s55, 24576
    s_add_u32 s49, s57, 122880
    buffer_load_dwordx4 v3, s[28:31], s49 offen lds
    s_add_u32 m0, s55, 12288
    s_add_u32 s48, s56, 122880
    buffer_load_dwordx4 v2, s[24:27], s48 offen lds
    s_add_u32 m0, s55, 28672
    s_add_u32 s49, s57, 184320
    buffer_load_dwordx4 v3, s[28:31], s49 offen lds
    s_add_u32 s74, s74, 1
    s_cmp_eq_u32 s74, 10
    s_cselect_b32 s74, s58, s74
    s_cmp_eq_u32 s54, 1
    s_cselect_b32 s74, s73, s74
    s_cmp_lg_u32 s54, 9
    s_cbranch_scc1 L_ld_ns
    s_mov_b32 s74, s59
    s_mov_b32 s58, 0
    s_mov_b32 s24, s10
    s_and_b32 s25, s11, 0xffff
    s_mov_b32 s26, 2621440
    s_mov_b32 s27, 0x00020000
    s_mov_b32 s28, s12
    s_and_b32 s29, s13, 0xffff
    s_mov_b32 s30, 2457600
    s_mov_b32 s31, 0x00020000
L_ld_ns:
    s_lshl_b32 s48, s74, 7
    s_add_u32 s56, s75, s48
    s_mul_i32 s48, s74, 245760
    s_add_u32 s57, s76, s48
    s_add_u32 s55, s55, 32768
    s_cmp_ge_u32 s55, 163840
    s_cselect_b32 s48, 98304, 0
    s_sub_u32 s55, s55, s48
    s_add_u32 s54, s54, 1
    s_cmp_lt_u32 s54, 19
    s_cbranch_scc1 L_ld_loop
    s_waitcnt lgkmcnt(0)
    s_mov_b32 s32, s20
    s_and_b32 s33, s21, 0xffff
    s_mov_b32 s34, 268435456
    s_mov_b32 s35, 0x00020000
    s_mov_b32 s36, s16
    s_and_b32 s37, s17, 0xffff
    s_mov_b32 s38, 5242880
    s_mov_b32 s39, 0x00020000
    s_load_dwordx2 s[78:79], s[18:19], 0
    v_bfe_u32 v172, v0, 3, 1
    v_mul_u32_u24 v172, 19, v172
    s_mul_i32 s48, s45, 20
    v_add_u32 v172, s48, v172
    v_lshrrev_b32 v172, 7, v172
    v_lshrrev_b32 v173, 4, v0
    v_min_u32 v173, 2, v173
    v_mad_u32_u24 v172, v173, 5, v172
    s_mul_i32 s48, s42, 33024
    v_and_b32 v170, 7, v0
    s_mov_b64 exec, 0xffff
    v_mov_b32 v170, s46
    s_mov_b64 exec, -1
    v_lshl_add_u32 v170, v172, 3, v170
    v_lshl_add_u32 v170, v170, 7, s48
    s_waitcnt vmcnt(8)
    s_barrier
    s_cmp_lg_u32 s40, 4
    s_cbranch_scc1 L_ld_nf
    buffer_load_dwordx4 v[172:175], v170, s[32:35], s47 offen sc1
L_ld_nf:
    s_add_u32 m0, s55, 0
    s_add_u32 s48, s56, 0
    buffer_load_dwordx4 v2, s[24:27], s48 offen lds
    s_add_u32 m0, s55, 16384
    s_add_u32 s49, s57, 0
    buffer_load_dwordx4 v3, s[28:31], s49 offen lds
    s_add_u32 m0, s55, 4096
    s_add_u32 s48, s56, 40960
    buffer_load_dwordx4 v2, s[24:27], s48 offen lds
    s_add_u32 m0, s55, 20480
    s_add_u32 s49, s57, 61440
    buffer_load_dwordx4 v3, s[28:31], s49 offen lds
    s_add_u32 m0, s55, 8192
    s_add_u32 s48, s56, 81920
    buffer_load_dwordx4 v2, s[24:27], s48 offen lds
    s_add_u32 m0, s55, 24576
    s_add_u32 s49, s57, 122880
    buffer_load_dwordx4 v3, s[28:31], s49 offen lds
    s_add_u32 m0, s55, 12288
    s_add_u32 s48, s56, 122880
    buffer_load_dwordx4 v2, s[24:27], s48 offen lds
    s_add_u32 m0, s55, 28672
    s_add_u32 s49, s57, 184320
    buffer_load_dwordx4 v3, s[28:31], s49 offen lds
L_ld_su:
    s_mov_b32 s28, 0
    v_mov_b64 v[240:241], 0
    v_mov_b64 v[242:243], 0
    v_mov_b64 v[244:245], 0
    v_mov_b64 v[246:247], 0
    s_lshl_b32 s56, s46, 3
    s_add_u32 s56, s56, s40
    v_lshlrev_b32 v1, 4, v0
    s_mul_i32 s60, s45, 81920
    s_lshr_b32 s48, s56, 1
    v_and_b32 v23, 0x1f0, v1
    s_mul_i32 s48, s48, 2560
    s_add_u32 s60, s60, s48
    s_add_u32 s60, s60, 5242880
    s_mov_b32 s64, -1
    s_mov_b32 s65, 0
    s_mov_b32 s66, 0
    s_mov_b32 s67, -1
    s_mov_b32 s68, 0xfffff
    s_mov_b32 s69, 0xfffff
    s_mov_b32 s70, 0xff800000
    s_mov_b32 s71, 0xff800000
    s_cmp_ge_u32 s40, 4
    s_mov_b32 s62, 0xc4
    s_cselect_b32 s62, 125, s62
    s_cselect_b32 s57, 7, 64
    s_cselect_b32 s58, 4, 6
    s_or_b32 s62, s62, s28
    v_lshrrev_b32 v17, 5, v0
    v_mov_b32 v2, v1
    v_lshl_add_u32 v3, v17, 3, v23
    v_add_u32 v3, 2048, v3
    v_and_b32 v16, 31, v0
    v_lshrrev_b32 v18, 3, v16
    v_xor_b32 v18, v18, v17
    v_and_b32 v18, 1, v18
    v_lshlrev_b32 v18, 6, v18
    v_and_b32 v19, 3, v16
    v_lshl_add_u32 v18, v19, 4, v18
    v_lshrrev_b32 v19, 2, v16
    v_lshl_add_u32 v4, v19, 7, v18
    v_add_u32 v4, 2560, v4
    v_mov_b64 v[16:17], 0
    s_mov_b32 exec_lo, 0x11000000
    s_mov_b32 exec_hi, 0x11000000
    v_mov_b32 v16, 0x3f803f80
    v_mov_b32 v17, 0x3f803f80
    s_mov_b64 exec, -1
    v_mov_b64 v[28:29], 0
    v_mov_b64 v[30:31], 0
    v_mov_b64 v[42:43], 0
    s_mov_b64 exec, s[64:65]
    v_mov_b32 v42, 0x3f80
    s_mov_b64 exec, -1
    v_bfe_u32 v18, v0, 4, 1
    v_mul_u32_u24 v18, 20480, v18
    v_and_b32 v19, 15, v0
    s_mul_i32 s48, s56, 40960
    v_lshl_add_u32 v18, v19, 4, v18
    v_lshrrev_b32 v19, 5, v0
    s_lshl_b32 s49, s45, 9
    s_add_u32 s49, s49, s48
    v_lshl_add_u32 v14, v19, 8, v18
    v_add_u32 v14, s49, v14
    s_lshr_b32 s49, s45, 3
    s_lshl_b32 s49, s49, 10
    s_add_u32 s48, s48, s49
    s_and_b32 s49, s45, 3
    s_lshl_b32 s49, s49, 8
    s_add_u32 s48, s48, s49
    s_and_b32 s49, s45, 4
    s_lshl_b32 s49, s49, 1
    s_add_u32 s48, s48, s49
    s_add_u32 s48, s48, 16384
    v_add_u32 v15, s48, v18
    s_lshl_b32 s55, s40, 10
    s_add_u32 s55, s55, 65536
    s_mov_b32 s59, 20480
    s_lshr_b32 s48, s56, 1
    s_lshl_b32 s48, s48, 9
    s_lshl_b32 s49, s45, 4
    s_add_u32 s48, s48, s49
    s_and_b32 s49, s56, 1
    s_lshl_b32 s49, s49, 3
    s_add_u32 s48, s48, s49
    s_add_u32 s22, s48, 25231360
    v_mov_b64 v[136:137], v[16:17]
    v_mov_b64 v[138:139], v[16:17]
    v_mov_b64 v[140:141], v[16:17]
    v_mov_b64 v[142:143], v[16:17]
    v_mov_b64 v[144:145], v[16:17]
    v_mov_b64 v[146:147], v[16:17]
    v_mov_b64 v[148:149], v[16:17]
    v_mov_b64 v[150:151], v[16:17]
    v_mov_b64 v[152:153], v[16:17]
    v_mov_b64 v[154:155], v[16:17]
    v_mov_b64 v[156:157], v[16:17]
    v_mov_b64 v[158:159], v[16:17]
    v_mov_b64 v[160:161], v[16:17]
    v_mov_b64 v[162:163], v[16:17]
    v_mov_b64 v[164:165], v[16:17]
    v_mov_b64 v[166:167], v[16:17]
    v_mov_b64 v[168:169], 0
    s_waitcnt vmcnt(8)
    s_waitcnt lgkmcnt(0)
    s_cmp_lg_u64 s[78:79], 0
    s_cbranch_scc1 L_gn1_done
    v_mov_b32 v18, 0
    s_mov_b32 s72, 0x4000
L_gn1:
    global_load_dwordx2 v[20:21], v18, s[18:19] sc1
    s_sub_u32 s72, s72, 1
    s_waitcnt vmcnt(0)
    v_readfirstlane_b32 s78, v20
    v_readfirstlane_b32 s79, v21
    s_cmp_eq_u32 s72, 0
    s_cbranch_scc1 L_gn1_done
    s_sleep 8
    s_cmp_eq_u64 s[78:79], 0
    s_cbranch_scc1 L_gn1
L_gn1_done:
    s_cmp_lg_u32 s40, 4
    s_cbranch_scc1 L_gpoll_done
    s_mov_b32 s72, 0x4000
L_gpoll:
    v_cmp_ne_u64 vcc, s[78:79], v[172:173]
    v_cmp_ne_u64 s[48:49], s[78:79], v[174:175]
    s_nop 0
    s_or_b64 vcc, vcc, s[48:49]
    s_cbranch_scc0 L_gpoll_done
    s_sub_u32 s72, s72, 1
    s_cbranch_scc1 L_gpoll_done
    s_sleep 2
    s_mov_b64 exec, vcc
    buffer_load_dwordx4 v[172:175], v170, s[32:35], s47 offen sc1
    s_mov_b64 exec, -1
    s_waitcnt vmcnt(0)
    s_branch L_gpoll
L_gpoll_done:
    s_barrier
    s_and_b32 s50, s56, 1
    s_lshl_b32 s48, s50, 10
    s_add_u32 s48, s48, s60
    s_lshl_b32 s49, s50, 3
    s_add_u32 s49, s49, s60
    buffer_load_dwordx4 v[24:27], v1, s[32:35], s48 offen sc1
    buffer_load_dwordx2 v[20:21], v23, s[32:35], s49 offen offset:2048 sc1
    s_sub_u32 s50, s55, 69632
    s_add_u32 s51, s50, s63
    s_add_u32 m0, s50, 0
    s_add_u32 s48, s51, 0
    buffer_load_dwordx4 v1, s[32:35], s48 offen sc1 lds
    s_add_u32 m0, s50, 4096
    s_add_u32 s48, s51, 4096
    buffer_load_dwordx4 v1, s[32:35], s48 offen sc1 lds
    s_add_u32 m0, s50, 8192
    s_add_u32 s48, s51, 8192
    buffer_load_dwordx4 v1, s[32:35], s48 offen sc1 lds
    s_add_u32 m0, s50, 12288
    s_add_u32 s48, s51, 12288
    buffer_load_dwordx4 v1, s[32:35], s48 offen sc1 lds
    s_add_u32 m0, s50, 16384
    s_add_u32 s48, s51, 16384
    buffer_load_dwordx4 v1, s[32:35], s48 offen sc1 lds
    s_add_u32 m0, s50, 20480
    s_add_u32 s48, s51, 20480
    buffer_load_dwordx4 v1, s[32:35], s48 offen sc1 lds
    s_add_u32 m0, s50, 24576
    s_add_u32 s48, s51, 24576
    buffer_load_dwordx4 v1, s[32:35], s48 offen sc1 lds
    s_add_u32 m0, s50, 28672
    s_add_u32 s48, s51, 28672
    buffer_load_dwordx4 v1, s[32:35], s48 offen sc1 lds
    s_waitcnt vmcnt(10)
    s_barrier
    s_add_u32 m0, s50, 32768
    s_add_u32 s48, s51, 32768
    buffer_load_dwordx4 v1, s[32:35], s48 offen sc1 lds
    s_add_u32 m0, s50, 36864
    s_add_u32 s48, s51, 36864
    buffer_load_dwordx4 v1, s[32:35], s48 offen sc1 lds
    s_add_u32 m0, s50, 40960
    s_add_u32 s48, s51, 40960
    buffer_load_dwordx4 v1, s[32:35], s48 offen sc1 lds
    s_add_u32 m0, s50, 45056
    s_add_u32 s48, s51, 45056
    buffer_load_dwordx4 v1, s[32:35], s48 offen sc1 lds
    s_add_u32 m0, s50, 49152
    s_add_u32 s48, s51, 49152
    buffer_load_dwordx4 v1, s[32:35], s48 offen sc1 lds
    s_add_u32 m0, s50, 53248
    s_add_u32 s48, s51, 53248
    buffer_load_dwordx4 v1, s[32:35], s48 offen sc1 lds
    s_add_u32 m0, s50, 57344
    s_add_u32 s48, s51, 57344
    buffer_load_dwordx4 v1, s[32:35], s48 offen sc1 lds
    s_add_u32 m0, s50, 61440
    s_add_u32 s48, s51, 61440
    buffer_load_dwordx4 v1, s[32:35], s48 offen sc1 lds
    s_waitcnt vmcnt(8)
    s_branch L_attn
L_comp:
    s_waitcnt lgkmcnt(0)
    s_mov_b32 s32, s20
    s_and_b32 s33, s21, 0xffff
    s_mov_b32 s34, 268435456
    s_mov_b32 s35, 0x00020000
    s_mov_b32 s36, s16
    s_and_b32 s37, s17, 0xffff
    s_mov_b32 s38, 5242880
    s_mov_b32 s39, 0x00020000
    s_or_b32 s48, s2, s40
    s_cmp_lg_u32 s48, 0
    s_cbranch_scc1 L_nononce
    s_memrealtime s[78:79]
    v_mov_b32 v1, 0
    s_waitcnt lgkmcnt(0)
    s_or_b32 s78, s78, 1
    v_mov_b32 v2, s78
    v_mov_b32 v3, s79
    s_mov_b64 exec, 1
    global_store_dwordx2 v1, v[2:3], s[18:19] sc1
    s_mov_b64 exec, -1
L_nononce:
    v_and_b32 v16, 31, v0
    v_lshrrev_b32 v17, 5, v0
    s_and_b32 s50, s40, 1
    s_lshr_b32 s51, s40, 1
    v_bfe_u32 v18, v0, 1, 3
    v_xor_b32 v18, v18, v17
    s_lshl_b32 s48, s50, 13
    s_add_u32 s48, s48, 98304
    v_lshl_add_u32 v19, v16, 7, s48
    v_xor_b32 v20, 0, v18
    v_lshl_add_u32 v5, v20, 4, v19
    v_xor_b32 v20, 2, v18
    v_lshl_add_u32 v6, v20, 4, v19
    v_xor_b32 v20, 4, v18
    v_lshl_add_u32 v7, v20, 4, v19
    v_xor_b32 v20, 6, v18
    v_lshl_add_u32 v8, v20, 4, v19
    v_bfe_u32 v18, v0, 2, 2
    v_and_b32 v19, 1, v0
    v_bfe_u32 v20, v0, 1, 1
    s_cmp_ge_u32 s43, 10
    s_cbranch_scc1 L_gc_v1
    v_swap_b32 v19, v20
L_gc_v1:
    v_bfe_u32 v21, v0, 4, 1
    v_lshl_add_u32 v20, v21, 1, v20
    v_lshl_add_u32 v21, v17, 3, v18
    v_lshlrev_b32 v21, 8, v21
    v_lshl_add_u32 v21, v19, 3, v21
    v_lshl_add_u32 v21, v20, 4, v21
    v_add_u32 v21, 114688, v21
    s_lshl_b32 s48, s51, 1
    s_add_u32 s48, s48, 0
    v_xor_b32 v22, s48, v18
    v_lshl_add_u32 v9, v22, 6, v21
    s_lshl_b32 s48, s51, 1
    s_add_u32 s48, s48, 1
    v_xor_b32 v22, s48, v18
    v_lshl_add_u32 v10, v22, 6, v21
    s_mov_b32 s12, 0
    s_mov_b32 s13, 1
    s_mov_b32 s15, 32768
    s_mov_b32 s28, 12
    s_mov_b32 s26, 8388608
    s_cmp_eq_u32 s40, 0
    s_cselect_b32 s29, 16384, 0
    s_bitset1_b32 s29, 19
    v_mov_b64 v[108:109], 0
    v_mov_b64 v[110:111], 0
    v_mov_b64 v[112:113], 0
    v_mov_b64 v[114:115], 0
    v_mov_b64 v[116:117], 0
    v_mov_b64 v[118:119], 0
    v_mov_b64 v[120:121], 0
    v_mov_b64 v[122:123], 0
    v_mov_b64 v[124:125], 0
    v_mov_b64 v[126:127], 0
    v_mov_b64 v[128:129], 0
    v_mov_b64 v[130:131], 0
    v_mov_b64 v[132:133], 0
    v_mov_b64 v[134:135], 0
    v_mov_b64 v[136:137], 0
    v_mov_b64 v[138:139], 0
    v_mov_b64 v[140:141], 0
    v_mov_b64 v[142:143], 0
    v_mov_b64 v[144:145], 0
    v_mov_b64 v[146:147], 0
    v_mov_b64 v[148:149], 0
    v_mov_b64 v[150:151], 0
    v_mov_b64 v[152:153], 0
    v_mov_b64 v[154:155], 0
    v_mov_b64 v[156:157], 0
    v_mov_b64 v[158:159], 0
    v_mov_b64 v[160:161], 0
    v_mov_b64 v[162:163], 0
    v_mov_b64 v[164:165], 0
    v_mov_b64 v[166:167], 0
    v_mov_b64 v[168:169], 0
    v_mov_b64 v[170:171], 0
    v_mov_b64 v[176:177], 0
    v_mov_b64 v[178:179], 0
    v_mov_b64 v[180:181], 0
    v_mov_b64 v[182:183], 0
    v_mov_b64 v[184:185], 0
    v_mov_b64 v[186:187], 0
    v_mov_b64 v[188:189], 0
    v_mov_b64 v[190:191], 0
    v_mov_b64 v[192:193], 0
    v_mov_b64 v[194:195], 0
    v_mov_b64 v[196:197], 0
    v_mov_b64 v[198:199], 0
    v_mov_b64 v[200:201], 0
    v_mov_b64 v[202:203], 0
    v_mov_b64 v[204:205], 0
    v_mov_b64 v[206:207], 0
    v_mov_b64 v[208:209], 0
    v_mov_b64 v[210:211], 0
    v_mov_b64 v[212:213], 0
    v_mov_b64 v[214:215], 0
    v_mov_b64 v[216:217], 0
    v_mov_b64 v[218:219], 0
    v_mov_b64 v[220:221], 0
    v_mov_b64 v[222:223], 0
    v_mov_b64 v[224:225], 0
    v_mov_b64 v[226:227], 0
    v_mov_b64 v[228:229], 0
    v_mov_b64 v[230:231], 0
    v_mov_b64 v[232:233], 0
    v_mov_b64 v[234:235], 0
    v_mov_b64 v[236:237], 0
    v_mov_b64 v[238:239], 0
    s_lshl1_add_u32 s52, s44, s50
    s_cmp_ge_u32 s43, 10
    s_cbranch_scc1 L_gv
    s_cmp_lt_u32 s43, 5
    s_cselect_b32 s30, 0x3ea52b5c, 1.0
    s_cselect_b32 s48, 5242880, 0
    s_cselect_b32 s53, 0, 1
    s_cselect_b32 s50, 0, 5
    s_lshl_b32 s49, 81920, s53
    s_lshl_b32 s53, 2560, s53
    s_mov_b32 s31, s30
    s_mul_i32 s52, s52, s53
    s_add_u32 s48, s48, s52
    s_sub_u32 s50, s43, s50
    s_lshl_b32 s50, s50, 4
    s_lshl_b32 s51, s51, 3
    s_add_u32 s50, s50, s51
    v_lshl_add_u32 v18, v16, 4, s48
    v_add_u32 v19, s50, v17
    v_mov_b32 v24, s49
    v_mov_b32 v25, 1024
    v_add_u32 v20, 0, v19
    v_mul_u32_u24 v21, 205, v20
    v_lshrrev_b32 v21, 10, v21
    v_mul_u32_u24 v22, 5, v21
    v_sub_u32 v22, v20, v22
    v_lshlrev_b32 v21, 1, v21
    v_cmp_lt_u32 vcc, 2, v22
    v_cmp_eq_u32 s[4:5], 2, v22
    s_nop 0
    v_addc_co_u32 v21, vcc, 0, v21, vcc
    v_cmp_lt_u32 vcc, 2, v22
    v_subrev_u32 v23, 3, v22
    s_nop 0
    v_cndmask_b32 v22, v22, v23, vcc
    v_cndmask_b32 v22, v22, 4, s[4:5]
    v_mul_lo_u32 v21, v21, v24
    v_lshl_add_u32 v21, v22, 9, v21
    v_add_u32 v240, v21, v18
    v_cndmask_b32 v23, v25, v24, s[4:5]
    v_add_u32 v241, v240, v23
    v_add_u32 v20, 2, v19
    v_mul_u32_u24 v21, 205, v20
    v_lshrrev_b32 v21, 10, v21
    v_mul_u32_u24 v22, 5, v21
    v_sub_u32 v22, v20, v22
    v_lshlrev_b32 v21, 1, v21
    v_cmp_lt_u32 vcc, 2, v22
    v_cmp_eq_u32 s[6:7], 2, v22
    s_nop 0
    v_addc_co_u32 v21, vcc, 0, v21, vcc
    v_cmp_lt_u32 vcc, 2, v22
    v_subrev_u32 v23, 3, v22
    s_nop 0
    v_cndmask_b32 v22, v22, v23, vcc
    v_cndmask_b32 v22, v22, 4, s[6:7]
    v_mul_lo_u32 v21, v21, v24
    v_lshl_add_u32 v21, v22, 9, v21
    v_add_u32 v242, v21, v18
    v_cndmask_b32 v23, v25, v24, s[6:7]
    v_add_u32 v243, v242, v23
    v_add_u32 v20, 4, v19
    v_mul_u32_u24 v21, 205, v20
    v_lshrrev_b32 v21, 10, v21
    v_mul_u32_u24 v22, 5, v21
    v_sub_u32 v22, v20, v22
    v_lshlrev_b32 v21, 1, v21
    v_cmp_lt_u32 vcc, 2, v22
    v_cmp_eq_u32 s[8:9], 2, v22
    s_nop 0
    v_addc_co_u32 v21, vcc, 0, v21, vcc
    v_cmp_lt_u32 vcc, 2, v22
    v_subrev_u32 v23, 3, v22
    s_nop 0
    v_cndmask_b32 v22, v22, v23, vcc
    v_cndmask_b32 v22, v22, 4, s[8:9]
    v_mul_lo_u32 v21, v21, v24
    v_lshl_add_u32 v21, v22, 9, v21
    v_add_u32 v244, v21, v18
    v_cndmask_b32 v23, v25, v24, s[8:9]
    v_add_u32 v245, v244, v23
    v_add_u32 v20, 6, v19
    v_mul_u32_u24 v21, 205, v20
    v_lshrrev_b32 v21, 10, v21
    v_mul_u32_u24 v22, 5, v21
    v_sub_u32 v22, v20, v22
    v_lshlrev_b32 v21, 1, v21
    v_cmp_lt_u32 vcc, 2, v22
    v_cmp_eq_u32 s[10:11], 2, v22
    s_nop 0
    v_addc_co_u32 v21, vcc, 0, v21, vcc
    v_cmp_lt_u32 vcc, 2, v22
    v_subrev_u32 v23, 3, v22
    s_nop 0
    v_cndmask_b32 v22, v22, v23, vcc
    v_cndmask_b32 v22, v22, 4, s[10:11]
    v_mul_lo_u32 v21, v21, v24
    v_lshl_add_u32 v21, v22, 9, v21
    v_add_u32 v246, v21, v18
    v_cndmask_b32 v23, v25, v24, s[10:11]
    v_add_u32 v247, v246, v23
    s_branch L_gsu
L_gv:
    s_sub_u32 s48, s43, 10
    s_lshl_b32 s48, s48, 7
    s_lshl_b32 s51, s51, 6
    s_add_u32 s48, s48, s51
    s_mul_i32 s52, s52, 5120
    s_add_u32 s52, s52, 2560
    v_mov_b32 v24, 163840
    v_add_u32 v19, s48, v16
    v_mul_u32_u24 v20, 3277, v19
    v_lshrrev_b32 v20, 16, v20
    v_mul_u32_u24 v21, 20, v20
    v_sub_u32 v21, v19, v21
    v_mul_lo_u32 v20, v20, v24
    v_lshrrev_b32 v22, 3, v21
    v_xor_b32 v22, v22, v17
    v_and_b32 v22, 1, v22
    v_lshlrev_b32 v22, 6, v22
    v_and_b32 v23, 3, v21
    v_lshl_add_u32 v22, v23, 4, v22
    v_lshrrev_b32 v23, 2, v21
    v_lshl_add_u32 v18, v23, 7, v22
    v_add3_u32 v240, v20, v18, s52
    v_add_u32 v241, 1280, v240
    v_add_u32 v242, 640, v240
    v_add_u32 v243, 1920, v240
    v_add_u32 v19, s48, v16
    v_add_u32 v19, 32, v19
    v_mul_u32_u24 v20, 3277, v19
    v_lshrrev_b32 v20, 16, v20
    v_mul_u32_u24 v21, 20, v20
    v_sub_u32 v21, v19, v21
    v_mul_lo_u32 v20, v20, v24
    v_lshrrev_b32 v22, 3, v21
    v_xor_b32 v22, v22, v17
    v_and_b32 v22, 1, v22
    v_lshlrev_b32 v22, 6, v22
    v_and_b32 v23, 3, v21
    v_lshl_add_u32 v22, v23, 4, v22
    v_lshrrev_b32 v23, 2, v21
    v_lshl_add_u32 v18, v23, 7, v22
    v_add3_u32 v244, v20, v18, s52
    v_add_u32 v245, 1280, v244
    v_add_u32 v246, 640, v244
    v_add_u32 v247, 1920, v244
L_gsu:
    s_lshl_b32 s56, s46, 3
    s_add_u32 s56, s56, s40
    v_lshlrev_b32 v1, 4, v0
    s_mul_i32 s60, s45, 81920
    s_lshr_b32 s48, s56, 1
    v_and_b32 v23, 0x1f0, v1
    s_mul_i32 s48, s48, 2560
    s_add_u32 s60, s60, s48
    s_add_u32 s60, s60, 5242880
    s_mov_b32 s64, -1
    s_mov_b32 s65, 0
    s_mov_b32 s66, 0
    s_mov_b32 s67, -1
    s_mov_b32 s68, 0xfffff
    s_mov_b32 s69, 0xfffff
    s_mov_b32 s70, 0xff800000
    s_mov_b32 s71, 0xff800000
    s_cmp_ge_u32 s40, 4
    s_mov_b32 s62, 0xc4
    s_cselect_b32 s62, 125, s62
    s_cselect_b32 s57, 7, 64
    s_cselect_b32 s58, 4, 6
    s_or_b32 s62, s62, s28
    v_lshrrev_b32 v17, 5, v0
    v_mov_b32 v2, v1
    v_lshl_add_u32 v3, v17, 3, v23
    v_add_u32 v3, 2048, v3
    v_and_b32 v16, 31, v0
    v_lshrrev_b32 v18, 3, v16
    v_xor_b32 v18, v18, v17
    v_and_b32 v18, 1, v18
    v_lshlrev_b32 v18, 6, v18
    v_and_b32 v19, 3, v16
    v_lshl_add_u32 v18, v19, 4, v18
    v_lshrrev_b32 v19, 2, v16
    v_lshl_add_u32 v4, v19, 7, v18
    v_add_u32 v4, 2560, v4
    v_mov_b64 v[16:17], 0
    s_mov_b32 exec_lo, 0x11000000
    s_mov_b32 exec_hi, 0x11000000
    v_mov_b32 v16, 0x3f803f80
    v_mov_b32 v17, 0x3f803f80
    s_mov_b64 exec, -1
    v_mov_b64 v[28:29], 0
    v_mov_b64 v[30:31], 0
    v_mov_b64 v[42:43], 0
    s_mov_b64 exec, s[64:65]
    v_mov_b32 v42, 0x3f80
    s_mov_b64 exec, -1
    v_bfe_u32 v18, v0, 4, 1
    v_mul_u32_u24 v18, 20480, v18
    v_and_b32 v19, 15, v0
    s_mul_i32 s48, s56, 40960
    v_lshl_add_u32 v18, v19, 4, v18
    v_lshrrev_b32 v19, 5, v0
    s_lshl_b32 s49, s45, 9
    s_add_u32 s49, s49, s48
    v_lshl_add_u32 v14, v19, 8, v18
    v_add_u32 v14, s49, v14
    s_lshr_b32 s49, s45, 3
    s_lshl_b32 s49, s49, 10
    s_add_u32 s48, s48, s49
    s_and_b32 s49, s45, 3
    s_lshl_b32 s49, s49, 8
    s_add_u32 s48, s48, s49
    s_and_b32 s49, s45, 4
    s_lshl_b32 s49, s49, 1
    s_add_u32 s48, s48, s49
    s_add_u32 s48, s48, 16384
    v_add_u32 v15, s48, v18
    s_lshl_b32 s55, s40, 10
    s_add_u32 s55, s55, 65536
    s_mov_b32 s59, 20480
    s_lshr_b32 s48, s56, 1
    s_lshl_b32 s48, s48, 9
    s_lshl_b32 s49, s45, 4
    s_add_u32 s48, s48, s49
    s_and_b32 s49, s56, 1
    s_lshl_b32 s49, s49, 3
    s_add_u32 s48, s48, s49
    s_add_u32 s22, s48, 25231360
    s_cmp_ge_u32 s43, 10
    s_barrier
    ds_read_b128 v[44:47], v5 offset:0
    ds_read_b64_tr_b16 v[52:53], v9 offset:0
    ds_read_b64_tr_b16 v[54:55], v9 offset:1024
    ds_read_b128 v[48:51], v5 offset:4096
    ds_read_b64_tr_b16 v[56:57], v10 offset:0
    ds_read_b64_tr_b16 v[58:59], v10 offset:1024
    ds_read_b128 v[60:63], v6 offset:0
    ds_read_b64_tr_b16 v[68:69], v9 offset:4096
    ds_read_b64_tr_b16 v[70:71], v9 offset:5120
    ds_read_b128 v[64:67], v6 offset:4096
    ds_read_b64_tr_b16 v[72:73], v10 offset:4096
    ds_read_b64_tr_b16 v[74:75], v10 offset:5120
    s_cbranch_scc1 L_ga_v
L_ga_qk:
    s_waitcnt lgkmcnt(6)
    v_mfma_f32_32x32x16_bf16 v[108:123], v[52:55], v[44:47], v[108:123]
    ds_read_b128 v[76:79], v7 offset:0
    ds_read_b64_tr_b16 v[84:85], v9 offset:8192
    v_mfma_f32_32x32x16_bf16 v[124:139], v[52:55], v[48:51], v[124:139]
    ds_read_b64_tr_b16 v[86:87], v9 offset:9216
    ds_read_b128 v[80:83], v7 offset:4096
    v_mfma_f32_32x32x16_bf16 v[140:155], v[56:59], v[44:47], v[140:155]
    ds_read_b64_tr_b16 v[88:89], v10 offset:8192
    ds_read_b64_tr_b16 v[90:91], v10 offset:9216
    v_mfma_f32_32x32x16_bf16 v[156:171], v[56:59], v[48:51], v[156:171]
    s_waitcnt lgkmcnt(6)
    v_mfma_f32_32x32x16_bf16 v[108:123], v[68:71], v[60:63], v[108:123]
    ds_read_b128 v[92:95], v8 offset:0
    ds_read_b64_tr_b16 v[100:101], v9 offset:12288
    v_mfma_f32_32x32x16_bf16 v[124:139], v[68:71], v[64:67], v[124:139]
    ds_read_b64_tr_b16 v[102:103], v9 offset:13312
    ds_read_b128 v[96:99], v8 offset:4096
    v_mfma_f32_32x32x16_bf16 v[140:155], v[72:75], v[60:63], v[140:155]
    ds_read_b64_tr_b16 v[104:105], v10 offset:12288
    ds_read_b64_tr_b16 v[106:107], v10 offset:13312
    v_mfma_f32_32x32x16_bf16 v[156:171], v[72:75], v[64:67], v[156:171]
    s_add_u32 s13, s13, 1
    s_cmp_eq_u32 s13, 3
    s_cselect_b32 s14, 4294901760, s15
    s_cselect_b32 s13, 0, s13
    v_add_u32 v5, s14, v5
    v_add_u32 v6, s14, v6
    v_add_u32 v7, s14, v7
    v_add_u32 v8, s14, v8
    v_add_u32 v9, s14, v9
    v_add_u32 v10, s14, v10
    s_add_u32 s12, s12, 1
    s_waitcnt lgkmcnt(6)
    v_mfma_f32_32x32x16_bf16 v[108:123], v[84:87], v[76:79], v[108:123]
    s_waitcnt lgkmcnt(0)
    s_barrier
    ds_read_b128 v[44:47], v5 offset:0
    ds_read_b64_tr_b16 v[52:53], v9 offset:0
    v_mfma_f32_32x32x16_bf16 v[124:139], v[84:87], v[80:83], v[124:139]
    ds_read_b64_tr_b16 v[54:55], v9 offset:1024
    ds_read_b128 v[48:51], v5 offset:4096
    v_mfma_f32_32x32x16_bf16 v[140:155], v[88:91], v[76:79], v[140:155]
    ds_read_b64_tr_b16 v[56:57], v10 offset:0
    ds_read_b64_tr_b16 v[58:59], v10 offset:1024
    v_mfma_f32_32x32x16_bf16 v[156:171], v[88:91], v[80:83], v[156:171]
    ds_read_b128 v[60:63], v6 offset:0
    ds_read_b64_tr_b16 v[68:69], v9 offset:4096
    v_mfma_f32_32x32x16_bf16 v[108:123], v[100:103], v[92:95], v[108:123]
    ds_read_b64_tr_b16 v[70:71], v9 offset:5120
    ds_read_b128 v[64:67], v6 offset:4096
    v_mfma_f32_32x32x16_bf16 v[124:139], v[100:103], v[96:99], v[124:139]
    ds_read_b64_tr_b16 v[72:73], v10 offset:4096
    ds_read_b64_tr_b16 v[74:75], v10 offset:5120
    v_mfma_f32_32x32x16_bf16 v[140:155], v[104:107], v[92:95], v[140:155]
    v_mfma_f32_32x32x16_bf16 v[156:171], v[104:107], v[96:99], v[156:171]
    s_cmp_lt_u32 s12, 10
    s_cbranch_scc1 L_ga_qk
    s_waitcnt lgkmcnt(6)
    v_mfma_f32_32x32x16_bf16 v[176:191], v[52:55], v[44:47], v[176:191]
    ds_read_b128 v[76:79], v7 offset:0
    ds_read_b64_tr_b16 v[84:85], v9 offset:8192
    v_mfma_f32_32x32x16_bf16 v[192:207], v[52:55], v[48:51], v[192:207]
    ds_read_b64_tr_b16 v[86:87], v9 offset:9216
    ds_read_b128 v[80:83], v7 offset:4096
    v_mfma_f32_32x32x16_bf16 v[208:223], v[56:59], v[44:47], v[208:223]
    ds_read_b64_tr_b16 v[88:89], v10 offset:8192
    ds_read_b64_tr_b16 v[90:91], v10 offset:9216
    v_pk_mul_f32 v[108:109], v[108:109], s[30:31]
    v_cvt_pk_bf16_f32 v108, v108, v109
    v_pk_mul_f32 v[110:111], v[110:111], s[30:31]
    v_cvt_pk_bf16_f32 v109, v110, v111
    v_pk_mul_f32 v[112:113], v[112:113], s[30:31]
    v_cvt_pk_bf16_f32 v110, v112, v113
    v_mfma_f32_32x32x16_bf16 v[224:239], v[56:59], v[48:51], v[224:239]
    v_pk_mul_f32 v[114:115], v[114:115], s[30:31]
    v_cvt_pk_bf16_f32 v111, v114, v115
    v_pk_mul_f32 v[116:117], v[116:117], s[30:31]
    v_cvt_pk_bf16_f32 v112, v116, v117
    s_waitcnt lgkmcnt(6)
    v_mfma_f32_32x32x16_bf16 v[176:191], v[68:71], v[60:63], v[176:191]
    ds_read_b128 v[92:95], v8 offset:0
    ds_read_b64_tr_b16 v[100:101], v9 offset:12288
    v_pk_mul_f32 v[118:119], v[118:119], s[30:31]
    v_cvt_pk_bf16_f32 v113, v118, v119
    v_pk_mul_f32 v[120:121], v[120:121], s[30:31]
    v_cvt_pk_bf16_f32 v114, v120, v121
    v_mfma_f32_32x32x16_bf16 v[192:207], v[68:71], v[64:67], v[192:207]
    ds_read_b64_tr_b16 v[102:103], v9 offset:13312
    ds_read_b128 v[96:99], v8 offset:4096
    v_pk_mul_f32 v[122:123], v[122:123], s[30:31]
    v_cvt_pk_bf16_f32 v115, v122, v123
    v_pk_mul_f32 v[124:125], v[124:125], s[30:31]
    v_cvt_pk_bf16_f32 v124, v124, v125
    v_pk_mul_f32 v[126:127], v[126:127], s[30:31]
    v_cvt_pk_bf16_f32 v125, v126, v127
    v_mfma_f32_32x32x16_bf16 v[208:223], v[72:75], v[60:63], v[208:223]
    ds_read_b64_tr_b16 v[104:105], v10 offset:12288
    ds_read_b64_tr_b16 v[106:107], v10 offset:13312
    v_pk_mul_f32 v[128:129], v[128:129], s[30:31]
    v_cvt_pk_bf16_f32 v126, v128, v129
    v_pk_mul_f32 v[130:131], v[130:131], s[30:31]
    v_cvt_pk_bf16_f32 v127, v130, v131
    s_mov_b64 exec, s[4:5]
    v_swap_b32 v110, v124
    v_swap_b32 v111, v125
    s_mov_b64 exec, -1
    buffer_store_dwordx4 v[108:111], v240, s[32:35], 0 offen sc1
    buffer_store_dwordx4 v[124:127], v241, s[32:35], 0 offen sc1
    v_mfma_f32_32x32x16_bf16 v[224:239], v[72:75], v[64:67], v[224:239]
    v_pk_mul_f32 v[132:133], v[132:133], s[30:31]
    v_cvt_pk_bf16_f32 v128, v132, v133
    v_pk_mul_f32 v[134:135], v[134:135], s[30:31]
    v_cvt_pk_bf16_f32 v129, v134, v135
    s_add_u32 s13, s13, 1
    s_cmp_eq_u32 s13, 3
    s_cselect_b32 s14, 4294901760, s15
    s_cselect_b32 s13, 0, s13
    v_add_u32 v5, s14, v5
    v_add_u32 v6, s14, v6
    v_add_u32 v7, s14, v7
    v_add_u32 v8, s14, v8
    v_add_u32 v9, s14, v9
    v_add_u32 v10, s14, v10
    s_add_u32 s12, s12, 1
    s_waitcnt lgkmcnt(6)
    v_mfma_f32_32x32x16_bf16 v[176:191], v[84:87], v[76:79], v[176:191]
    v_pk_mul_f32 v[136:137], v[136:137], s[30:31]
    v_cvt_pk_bf16_f32 v130, v136, v137
    v_pk_mul_f32 v[138:139], v[138:139], s[30:31]
    v_cvt_pk_bf16_f32 v131, v138, v139
    s_mov_b64 exec, s[6:7]
    v_swap_b32 v114, v128
    v_swap_b32 v115, v129
    s_mov_b64 exec, -1
    buffer_store_dwordx4 v[112:115], v242, s[32:35], 0 offen sc1
    buffer_store_dwordx4 v[128:131], v243, s[32:35], 0 offen sc1
    s_waitcnt lgkmcnt(0)
    s_barrier
    ds_read_b128 v[44:47], v5 offset:0
    ds_read_b64_tr_b16 v[52:53], v9 offset:0
    v_mfma_f32_32x32x16_bf16 v[192:207], v[84:87], v[80:83], v[192:207]
    ds_read_b64_tr_b16 v[54:55], v9 offset:1024
    ds_read_b128 v[48:51], v5 offset:4096
    v_pk_mul_f32 v[140:141], v[140:141], s[30:31]
    v_cvt_pk_bf16_f32 v140, v140, v141
    v_pk_mul_f32 v[142:143], v[142:143], s[30:31]
    v_cvt_pk_bf16_f32 v141, v142, v143
    v_pk_mul_f32 v[144:145], v[144:145], s[30:31]
    v_cvt_pk_bf16_f32 v142, v144, v145
    v_mfma_f32_32x32x16_bf16 v[208:223], v[88:91], v[76:79], v[208:223]
    ds_read_b64_tr_b16 v[56:57], v10 offset:0
    ds_read_b64_tr_b16 v[58:59], v10 offset:1024
    v_pk_mul_f32 v[146:147], v[146:147], s[30:31]
    v_cvt_pk_bf16_f32 v143, v146, v147
    v_pk_mul_f32 v[148:149], v[148:149], s[30:31]
    v_cvt_pk_bf16_f32 v144, v148, v149
    v_mfma_f32_32x32x16_bf16 v[224:239], v[88:91], v[80:83], v[224:239]
    ds_read_b128 v[60:63], v6 offset:0
    ds_read_b64_tr_b16 v[68:69], v9 offset:4096
    v_pk_mul_f32 v[150:151], v[150:151], s[30:31]
    v_cvt_pk_bf16_f32 v145, v150, v151
    v_pk_mul_f32 v[152:153], v[152:153], s[30:31]
    v_cvt_pk_bf16_f32 v146, v152, v153
    v_mfma_f32_32x32x16_bf16 v[176:191], v[100:103], v[92:95], v[176:191]
    ds_read_b64_tr_b16 v[70:71], v9 offset:5120
    ds_read_b128 v[64:67], v6 offset:4096
    v_pk_mul_f32 v[154:155], v[154:155], s[30:31]
    v_cvt_pk_bf16_f32 v147, v154, v155
    v_pk_mul_f32 v[156:157], v[156:157], s[30:31]
    v_cvt_pk_bf16_f32 v156, v156, v157
    v_pk_mul_f32 v[158:159], v[158:159], s[30:31]
    v_cvt_pk_bf16_f32 v157, v158, v159
    v_mfma_f32_32x32x16_bf16 v[192:207], v[100:103], v[96:99], v[192:207]
    ds_read_b64_tr_b16 v[72:73], v10 offset:4096
    ds_read_b64_tr_b16 v[74:75], v10 offset:5120
    v_pk_mul_f32 v[160:161], v[160:161], s[30:31]
    v_cvt_pk_bf16_f32 v158, v160, v161
    v_pk_mul_f32 v[162:163], v[162:163], s[30:31]
    v_cvt_pk_bf16_f32 v159, v162, v163
    s_mov_b64 exec, s[8:9]
    v_swap_b32 v142, v156
    v_swap_b32 v143, v157
    s_mov_b64 exec, -1
    buffer_store_dwordx4 v[140:143], v244, s[32:35], 0 offen sc1
    buffer_store_dwordx4 v[156:159], v245, s[32:35], 0 offen sc1
    v_mfma_f32_32x32x16_bf16 v[208:223], v[104:107], v[92:95], v[208:223]
    v_pk_mul_f32 v[164:165], v[164:165], s[30:31]
    v_cvt_pk_bf16_f32 v160, v164, v165
    v_pk_mul_f32 v[166:167], v[166:167], s[30:31]
    v_cvt_pk_bf16_f32 v161, v166, v167
    v_mfma_f32_32x32x16_bf16 v[224:239], v[104:107], v[96:99], v[224:239]
    v_pk_mul_f32 v[168:169], v[168:169], s[30:31]
    v_cvt_pk_bf16_f32 v162, v168, v169
    v_pk_mul_f32 v[170:171], v[170:171], s[30:31]
    v_cvt_pk_bf16_f32 v163, v170, v171
    s_mov_b64 exec, s[10:11]
    v_swap_b32 v146, v160
    v_swap_b32 v147, v161
    s_mov_b64 exec, -1
    buffer_store_dwordx4 v[144:147], v246, s[32:35], 0 offen sc1
    buffer_store_dwordx4 v[160:163], v247, s[32:35], 0 offen sc1
    s_waitcnt lgkmcnt(6)
    v_mfma_f32_32x32x16_bf16 v[176:191], v[52:55], v[44:47], v[176:191]
    ds_read_b128 v[76:79], v7 offset:0
    ds_read_b64_tr_b16 v[84:85], v9 offset:8192
    v_mfma_f32_32x32x16_bf16 v[192:207], v[52:55], v[48:51], v[192:207]
    ds_read_b64_tr_b16 v[86:87], v9 offset:9216
    ds_read_b128 v[80:83], v7 offset:4096
    v_mov_b64 v[136:137], v[16:17]
    v_mov_b64 v[138:139], v[16:17]
    v_mfma_f32_32x32x16_bf16 v[208:223], v[56:59], v[44:47], v[208:223]
    ds_read_b64_tr_b16 v[88:89], v10 offset:8192
    ds_read_b64_tr_b16 v[90:91], v10 offset:9216
    v_mov_b64 v[140:141], v[16:17]
    v_mfma_f32_32x32x16_bf16 v[224:239], v[56:59], v[48:51], v[224:239]
    v_mov_b64 v[142:143], v[16:17]
    s_waitcnt lgkmcnt(6)
    v_mfma_f32_32x32x16_bf16 v[176:191], v[68:71], v[60:63], v[176:191]
    ds_read_b128 v[92:95], v8 offset:0
    ds_read_b64_tr_b16 v[100:101], v9 offset:12288
    v_mov_b64 v[144:145], v[16:17]
    v_mov_b64 v[146:147], v[16:17]
    v_mfma_f32_32x32x16_bf16 v[192:207], v[68:71], v[64:67], v[192:207]
    ds_read_b64_tr_b16 v[102:103], v9 offset:13312
    ds_read_b128 v[96:99], v8 offset:4096
    v_mov_b64 v[148:149], v[16:17]
    v_mfma_f32_32x32x16_bf16 v[208:223], v[72:75], v[60:63], v[208:223]
    ds_read_b64_tr_b16 v[104:105], v10 offset:12288
    ds_read_b64_tr_b16 v[106:107], v10 offset:13312
    v_mov_b64 v[150:151], v[16:17]
    v_mfma_f32_32x32x16_bf16 v[224:239], v[72:75], v[64:67], v[224:239]
    v_mov_b64 v[152:153], v[16:17]
    s_add_u32 s13, s13, 1
    s_cmp_eq_u32 s13, 3
    s_cselect_b32 s14, 4294901760, s15
    s_cselect_b32 s13, 0, s13
    v_add_u32 v5, s14, v5
    v_add_u32 v6, s14, v6
    v_add_u32 v7, s14, v7
    v_add_u32 v8, s14, v8
    v_add_u32 v9, s14, v9
    v_add_u32 v10, s14, v10
    s_add_u32 s12, s12, 1
    s_waitcnt lgkmcnt(6)
    v_mfma_f32_32x32x16_bf16 v[176:191], v[84:87], v[76:79], v[176:191]
    v_mov_b64 v[154:155], v[16:17]
    v_mov_b64 v[156:157], v[16:17]
    s_waitcnt lgkmcnt(0)
    s_barrier
    ds_read_b128 v[44:47], v5 offset:0
    ds_read_b64_tr_b16 v[52:53], v9 offset:0
    v_mfma_f32_32x32x16_bf16 v[192:207], v[84:87], v[80:83], v[192:207]
    ds_read_b64_tr_b16 v[54:55], v9 offset:1024
    ds_read_b128 v[48:51], v5 offset:4096
    v_mov_b64 v[158:159], v[16:17]
    v_mfma_f32_32x32x16_bf16 v[208:223], v[88:91], v[76:79], v[208:223]
    ds_read_b64_tr_b16 v[56:57], v10 offset:0
    ds_read_b64_tr_b16 v[58:59], v10 offset:1024
    v_mov_b64 v[160:161], v[16:17]
    v_mfma_f32_32x32x16_bf16 v[224:239], v[88:91], v[80:83], v[224:239]
    ds_read_b128 v[60:63], v6 offset:0
    ds_read_b64_tr_b16 v[68:69], v9 offset:4096
    v_mov_b64 v[162:163], v[16:17]
    v_mfma_f32_32x32x16_bf16 v[176:191], v[100:103], v[92:95], v[176:191]
    ds_read_b64_tr_b16 v[70:71], v9 offset:5120
    ds_read_b128 v[64:67], v6 offset:4096
    v_mov_b64 v[164:165], v[16:17]
    v_mov_b64 v[166:167], v[16:17]
    v_mfma_f32_32x32x16_bf16 v[192:207], v[100:103], v[96:99], v[192:207]
    ds_read_b64_tr_b16 v[72:73], v10 offset:4096
    ds_read_b64_tr_b16 v[74:75], v10 offset:5120
    v_mov_b64 v[168:169], 0
    v_mfma_f32_32x32x16_bf16 v[208:223], v[104:107], v[92:95], v[208:223]
    v_mov_b32 v170, 0
    v_mfma_f32_32x32x16_bf16 v[224:239], v[104:107], v[96:99], v[224:239]
    s_load_dwordx2 s[78:79], s[18:19], 0
L_gb_qk:
    s_waitcnt lgkmcnt(6)
    v_mfma_f32_32x32x16_bf16 v[176:191], v[52:55], v[44:47], v[176:191]
    ds_read_b128 v[76:79], v7 offset:0
    ds_read_b64_tr_b16 v[84:85], v9 offset:8192
    v_mfma_f32_32x32x16_bf16 v[192:207], v[52:55], v[48:51], v[192:207]
    ds_read_b64_tr_b16 v[86:87], v9 offset:9216
    ds_read_b128 v[80:83], v7 offset:4096
    v_mfma_f32_32x32x16_bf16 v[208:223], v[56:59], v[44:47], v[208:223]
    ds_read_b64_tr_b16 v[88:89], v10 offset:8192
    ds_read_b64_tr_b16 v[90:91], v10 offset:9216
    v_mfma_f32_32x32x16_bf16 v[224:239], v[56:59], v[48:51], v[224:239]
    s_waitcnt lgkmcnt(6)
    v_mfma_f32_32x32x16_bf16 v[176:191], v[68:71], v[60:63], v[176:191]
    ds_read_b128 v[92:95], v8 offset:0
    ds_read_b64_tr_b16 v[100:101], v9 offset:12288
    v_mfma_f32_32x32x16_bf16 v[192:207], v[68:71], v[64:67], v[192:207]
    ds_read_b64_tr_b16 v[102:103], v9 offset:13312
    ds_read_b128 v[96:99], v8 offset:4096
    v_mfma_f32_32x32x16_bf16 v[208:223], v[72:75], v[60:63], v[208:223]
    ds_read_b64_tr_b16 v[104:105], v10 offset:12288
    ds_read_b64_tr_b16 v[106:107], v10 offset:13312
    v_mfma_f32_32x32x16_bf16 v[224:239], v[72:75], v[64:67], v[224:239]
    s_add_u32 s13, s13, 1
    s_cmp_eq_u32 s13, 3
    s_cselect_b32 s14, 4294901760, s15
    s_cselect_b32 s13, 0, s13
    v_add_u32 v5, s14, v5
    v_add_u32 v6, s14, v6
    v_add_u32 v7, s14, v7
    v_add_u32 v8, s14, v8
    v_add_u32 v9, s14, v9
    v_add_u32 v10, s14, v10
    s_add_u32 s12, s12, 1
    s_cmp_eq_u32 s12, 20
    s_cbranch_scc1 L_ge_qk
    s_waitcnt lgkmcnt(6)
    v_mfma_f32_32x32x16_bf16 v[176:191], v[84:87], v[76:79], v[176:191]
    s_cmp_lt_u32 s12, 14
    s_cbranch_scc1 L_gw_qk
    s_waitcnt vmcnt(0)
L_gw_qk:
    s_bitcmp1_b32 s29, s12
    s_waitcnt lgkmcnt(0)
    s_barrier
    s_cbranch_scc1 L_gh
L_ghr_qk:
    ds_read_b128 v[44:47], v5 offset:0
    ds_read_b64_tr_b16 v[52:53], v9 offset:0
    v_mfma_f32_32x32x16_bf16 v[192:207], v[84:87], v[80:83], v[192:207]
    ds_read_b64_tr_b16 v[54:55], v9 offset:1024
    ds_read_b128 v[48:51], v5 offset:4096
    v_mfma_f32_32x32x16_bf16 v[208:223], v[88:91], v[76:79], v[208:223]
    ds_read_b64_tr_b16 v[56:57], v10 offset:0
    ds_read_b64_tr_b16 v[58:59], v10 offset:1024
    v_mfma_f32_32x32x16_bf16 v[224:239], v[88:91], v[80:83], v[224:239]
    ds_read_b128 v[60:63], v6 offset:0
    ds_read_b64_tr_b16 v[68:69], v9 offset:4096
    v_mfma_f32_32x32x16_bf16 v[176:191], v[100:103], v[92:95], v[176:191]
    ds_read_b64_tr_b16 v[70:71], v9 offset:5120
    ds_read_b128 v[64:67], v6 offset:4096
    v_mfma_f32_32x32x16_bf16 v[192:207], v[100:103], v[96:99], v[192:207]
    ds_read_b64_tr_b16 v[72:73], v10 offset:4096
    ds_read_b64_tr_b16 v[74:75], v10 offset:5120
    v_mfma_f32_32x32x16_bf16 v[208:223], v[104:107], v[92:95], v[208:223]
    v_mfma_f32_32x32x16_bf16 v[224:239], v[104:107], v[96:99], v[224:239]
    s_branch L_gb_qk
L_ge_qk:
    s_waitcnt lgkmcnt(0)
    s_cmp_ge_u32 s43, 5
    s_cbranch_scc1 L_nosc
    v_mfma_f32_32x32x16_bf16 v[176:191], v[84:87], v[76:79], v[176:191]
    v_mfma_f32_32x32x16_bf16 v[192:207], v[84:87], v[80:83], v[192:207]
    v_mfma_f32_32x32x16_bf16 v[176:191], v[100:103], v[92:95], v[176:191]
    v_mfma_f32_32x32x16_bf16 v[192:207], v[100:103], v[96:99], v[192:207]
    v_mfma_f32_32x32x16_bf16 v[208:223], v[88:91], v[76:79], v[208:223]
    v_mfma_f32_32x32x16_bf16 v[224:239], v[88:91], v[80:83], v[224:239]
    s_nop 7
    s_nop 1
    v_pk_mul_f32 v[176:177], v[176:177], s[30:31]
    v_cvt_pk_bf16_f32 v176, v176, v177
    v_pk_mul_f32 v[178:179], v[178:179], s[30:31]
    v_cvt_pk_bf16_f32 v177, v178, v179
    v_mfma_f32_32x32x16_bf16 v[208:223], v[104:107], v[92:95], v[208:223]
    v_pk_mul_f32 v[180:181], v[180:181], s[30:31]
    v_cvt_pk_bf16_f32 v178, v180, v181
    v_pk_mul_f32 v[182:183], v[182:183], s[30:31]
    v_cvt_pk_bf16_f32 v179, v182, v183
    v_pk_mul_f32 v[184:185], v[184:185], s[30:31]
    v_cvt_pk_bf16_f32 v180, v184, v185
    v_pk_mul_f32 v[186:187], v[186:187], s[30:31]
    v_cvt_pk_bf16_f32 v181, v186, v187
    v_mfma_f32_32x32x16_bf16 v[224:239], v[104:107], v[96:99], v[224:239]
    v_pk_mul_f32 v[188:189], v[188:189], s[30:31]
    v_cvt_pk_bf16_f32 v182, v188, v189
    v_pk_mul_f32 v[190:191], v[190:191], s[30:31]
    v_cvt_pk_bf16_f32 v183, v190, v191
    v_pk_mul_f32 v[192:193], v[192:193], s[30:31]
    v_cvt_pk_bf16_f32 v192, v192, v193
    v_pk_mul_f32 v[194:195], v[194:195], s[30:31]
    v_cvt_pk_bf16_f32 v193, v194, v195
    v_pk_mul_f32 v[196:197], v[196:197], s[30:31]
    v_cvt_pk_bf16_f32 v194, v196, v197
    v_pk_mul_f32 v[198:199], v[198:199], s[30:31]
    v_cvt_pk_bf16_f32 v195, v198, v199
    s_mov_b64 exec, s[4:5]
    v_swap_b32 v178, v192
    v_swap_b32 v179, v193
    s_mov_b64 exec, -1
    v_pk_mul_f32 v[200:201], v[200:201], s[30:31]
    v_cvt_pk_bf16_f32 v196, v200, v201
    v_pk_mul_f32 v[202:203], v[202:203], s[30:31]
    v_cvt_pk_bf16_f32 v197, v202, v203
    v_pk_mul_f32 v[204:205], v[204:205], s[30:31]
    v_cvt_pk_bf16_f32 v198, v204, v205
    v_pk_mul_f32 v[206:207], v[206:207], s[30:31]
    v_cvt_pk_bf16_f32 v199, v206, v207
    s_mov_b64 exec, s[6:7]
    v_swap_b32 v182, v196
    v_swap_b32 v183, v197
    s_mov_b64 exec, -1
    v_pk_mul_f32 v[208:209], v[208:209], s[30:31]
    v_cvt_pk_bf16_f32 v208, v208, v209
    v_pk_mul_f32 v[210:211], v[210:211], s[30:31]
    v_cvt_pk_bf16_f32 v209, v210, v211
    v_pk_mul_f32 v[212:213], v[212:213], s[30:31]
    v_cvt_pk_bf16_f32 v210, v212, v213
    v_pk_mul_f32 v[214:215], v[214:215], s[30:31]
    v_cvt_pk_bf16_f32 v211, v214, v215
    v_pk_mul_f32 v[216:217], v[216:217], s[30:31]
    v_cvt_pk_bf16_f32 v212, v216, v217
    v_pk_mul_f32 v[218:219], v[218:219], s[30:31]
    v_cvt_pk_bf16_f32 v213, v218, v219
    v_pk_mul_f32 v[220:221], v[220:221], s[30:31]
    v_cvt_pk_bf16_f32 v214, v220, v221
    v_pk_mul_f32 v[222:223], v[222:223], s[30:31]
    v_cvt_pk_bf16_f32 v215, v222, v223
    v_pk_mul_f32 v[224:225], v[224:225], s[30:31]
    v_cvt_pk_bf16_f32 v224, v224, v225
    v_pk_mul_f32 v[226:227], v[226:227], s[30:31]
    v_cvt_pk_bf16_f32 v225, v226, v227
    v_pk_mul_f32 v[228:229], v[228:229], s[30:31]
    v_cvt_pk_bf16_f32 v226, v228, v229
    v_pk_mul_f32 v[230:231], v[230:231], s[30:31]
    v_cvt_pk_bf16_f32 v227, v230, v231
    s_mov_b64 exec, s[8:9]
    v_swap_b32 v210, v224
    v_swap_b32 v211, v225
    s_mov_b64 exec, -1
    v_pk_mul_f32 v[232:233], v[232:233], s[30:31]
    v_cvt_pk_bf16_f32 v228, v232, v233
    v_pk_mul_f32 v[234:235], v[234:235], s[30:31]
    v_cvt_pk_bf16_f32 v229, v234, v235
    v_pk_mul_f32 v[236:237], v[236:237], s[30:31]
    v_cvt_pk_bf16_f32 v230, v236, v237
    v_pk_mul_f32 v[238:239], v[238:239], s[30:31]
    v_cvt_pk_bf16_f32 v231, v238, v239
    s_mov_b64 exec, s[10:11]
    v_swap_b32 v214, v228
    v_swap_b32 v215, v229
    s_mov_b64 exec, -1
    s_branch L_gfin
L_nosc:
    v_mfma_f32_32x32x16_bf16 v[176:191], v[84:87], v[76:79], v[176:191]
    v_mfma_f32_32x32x16_bf16 v[192:207], v[84:87], v[80:83], v[192:207]
    v_mfma_f32_32x32x16_bf16 v[176:191], v[100:103], v[92:95], v[176:191]
    v_mfma_f32_32x32x16_bf16 v[192:207], v[100:103], v[96:99], v[192:207]
    v_mfma_f32_32x32x16_bf16 v[208:223], v[88:91], v[76:79], v[208:223]
    v_mfma_f32_32x32x16_bf16 v[224:239], v[88:91], v[80:83], v[224:239]
    s_nop 7
    s_nop 1
    v_cvt_pk_bf16_f32 v176, v176, v177
    v_cvt_pk_bf16_f32 v177, v178, v179
    v_mfma_f32_32x32x16_bf16 v[208:223], v[104:107], v[92:95], v[208:223]
    v_cvt_pk_bf16_f32 v178, v180, v181
    v_cvt_pk_bf16_f32 v179, v182, v183
    v_cvt_pk_bf16_f32 v180, v184, v185
    v_cvt_pk_bf16_f32 v181, v186, v187
    v_mfma_f32_32x32x16_bf16 v[224:239], v[104:107], v[96:99], v[224:239]
    v_cvt_pk_bf16_f32 v182, v188, v189
    v_cvt_pk_bf16_f32 v183, v190, v191
    v_cvt_pk_bf16_f32 v192, v192, v193
    v_cvt_pk_bf16_f32 v193, v194, v195
    v_cvt_pk_bf16_f32 v194, v196, v197
    v_cvt_pk_bf16_f32 v195, v198, v199
    s_mov_b64 exec, s[4:5]
    v_swap_b32 v178, v192
    v_swap_b32 v179, v193
    s_mov_b64 exec, -1
    v_cvt_pk_bf16_f32 v196, v200, v201
    v_cvt_pk_bf16_f32 v197, v202, v203
    v_cvt_pk_bf16_f32 v198, v204, v205
    v_cvt_pk_bf16_f32 v199, v206, v207
    s_mov_b64 exec, s[6:7]
    v_swap_b32 v182, v196
    v_swap_b32 v183, v197
    s_mov_b64 exec, -1
    s_nop 3
    v_cvt_pk_bf16_f32 v208, v208, v209
    v_cvt_pk_bf16_f32 v209, v210, v211
    v_cvt_pk_bf16_f32 v210, v212, v213
    v_cvt_pk_bf16_f32 v211, v214, v215
    v_cvt_pk_bf16_f32 v212, v216, v217
    v_cvt_pk_bf16_f32 v213, v218, v219
    v_cvt_pk_bf16_f32 v214, v220, v221
    v_cvt_pk_bf16_f32 v215, v222, v223
    v_cvt_pk_bf16_f32 v224, v224, v225
    v_cvt_pk_bf16_f32 v225, v226, v227
    v_cvt_pk_bf16_f32 v226, v228, v229
    v_cvt_pk_bf16_f32 v227, v230, v231
    s_mov_b64 exec, s[8:9]
    v_swap_b32 v210, v224
    v_swap_b32 v211, v225
    s_mov_b64 exec, -1
    v_cvt_pk_bf16_f32 v228, v232, v233
    v_cvt_pk_bf16_f32 v229, v234, v235
    v_cvt_pk_bf16_f32 v230, v236, v237
    v_cvt_pk_bf16_f32 v231, v238, v239
    s_mov_b64 exec, s[10:11]
    v_swap_b32 v214, v228
    v_swap_b32 v215, v229
    s_mov_b64 exec, -1
    s_branch L_gfin
L_ga_v:
    s_waitcnt lgkmcnt(6)
    v_mfma_f32_32x32x16_bf16 v[108:123], v[44:47], v[52:55], v[108:123]
    ds_read_b128 v[76:79], v7 offset:0
    ds_read_b64_tr_b16 v[84:85], v9 offset:8192
    v_mfma_f32_32x32x16_bf16 v[124:139], v[48:51], v[52:55], v[124:139]
    ds_read_b64_tr_b16 v[86:87], v9 offset:9216
    ds_read_b128 v[80:83], v7 offset:4096
    v_mfma_f32_32x32x16_bf16 v[140:155], v[44:47], v[56:59], v[140:155]
    ds_read_b64_tr_b16 v[88:89], v10 offset:8192
    ds_read_b64_tr_b16 v[90:91], v10 offset:9216
    v_mfma_f32_32x32x16_bf16 v[156:171], v[48:51], v[56:59], v[156:171]
    s_waitcnt lgkmcnt(6)
    v_mfma_f32_32x32x16_bf16 v[108:123], v[60:63], v[68:71], v[108:123]
    ds_read_b128 v[92:95], v8 offset:0
    ds_read_b64_tr_b16 v[100:101], v9 offset:12288
    v_mfma_f32_32x32x16_bf16 v[124:139], v[64:67], v[68:71], v[124:139]
    ds_read_b64_tr_b16 v[102:103], v9 offset:13312
    ds_read_b128 v[96:99], v8 offset:4096
    v_mfma_f32_32x32x16_bf16 v[140:155], v[60:63], v[72:75], v[140:155]
    ds_read_b64_tr_b16 v[104:105], v10 offset:12288
    ds_read_b64_tr_b16 v[106:107], v10 offset:13312
    v_mfma_f32_32x32x16_bf16 v[156:171], v[64:67], v[72:75], v[156:171]
    s_add_u32 s13, s13, 1
    s_cmp_eq_u32 s13, 3
    s_cselect_b32 s14, 4294901760, s15
    s_cselect_b32 s13, 0, s13
    v_add_u32 v5, s14, v5
    v_add_u32 v6, s14, v6
    v_add_u32 v7, s14, v7
    v_add_u32 v8, s14, v8
    v_add_u32 v9, s14, v9
    v_add_u32 v10, s14, v10
    s_add_u32 s12, s12, 1
    s_waitcnt lgkmcnt(6)
    v_mfma_f32_32x32x16_bf16 v[108:123], v[76:79], v[84:87], v[108:123]
    s_waitcnt lgkmcnt(0)
    s_barrier
    ds_read_b128 v[44:47], v5 offset:0
    ds_read_b64_tr_b16 v[52:53], v9 offset:0
    v_mfma_f32_32x32x16_bf16 v[124:139], v[80:83], v[84:87], v[124:139]
    ds_read_b64_tr_b16 v[54:55], v9 offset:1024
    ds_read_b128 v[48:51], v5 offset:4096
    v_mfma_f32_32x32x16_bf16 v[140:155], v[76:79], v[88:91], v[140:155]
    ds_read_b64_tr_b16 v[56:57], v10 offset:0
    ds_read_b64_tr_b16 v[58:59], v10 offset:1024
    v_mfma_f32_32x32x16_bf16 v[156:171], v[80:83], v[88:91], v[156:171]
    ds_read_b128 v[60:63], v6 offset:0
    ds_read_b64_tr_b16 v[68:69], v9 offset:4096
    v_mfma_f32_32x32x16_bf16 v[108:123], v[92:95], v[100:103], v[108:123]
    ds_read_b64_tr_b16 v[70:71], v9 offset:5120
    ds_read_b128 v[64:67], v6 offset:4096
    v_mfma_f32_32x32x16_bf16 v[124:139], v[96:99], v[100:103], v[124:139]
    ds_read_b64_tr_b16 v[72:73], v10 offset:4096
    ds_read_b64_tr_b16 v[74:75], v10 offset:5120
    v_mfma_f32_32x32x16_bf16 v[140:155], v[92:95], v[104:107], v[140:155]
    v_mfma_f32_32x32x16_bf16 v[156:171], v[96:99], v[104:107], v[156:171]
    s_cmp_lt_u32 s12, 10
    s_cbranch_scc1 L_ga_v
    s_waitcnt lgkmcnt(6)
    v_mfma_f32_32x32x16_bf16 v[176:191], v[44:47], v[52:55], v[176:191]
    ds_read_b128 v[76:79], v7 offset:0
    ds_read_b64_tr_b16 v[84:85], v9 offset:8192
    v_mfma_f32_32x32x16_bf16 v[192:207], v[48:51], v[52:55], v[192:207]
    ds_read_b64_tr_b16 v[86:87], v9 offset:9216
    ds_read_b128 v[80:83], v7 offset:4096
    v_mfma_f32_32x32x16_bf16 v[208:223], v[44:47], v[56:59], v[208:223]
    ds_read_b64_tr_b16 v[88:89], v10 offset:8192
    ds_read_b64_tr_b16 v[90:91], v10 offset:9216
    v_cvt_pk_bf16_f32 v108, v108, v109
    v_cvt_pk_bf16_f32 v109, v110, v111
    v_cvt_pk_bf16_f32 v110, v112, v113
    v_mfma_f32_32x32x16_bf16 v[224:239], v[48:51], v[56:59], v[224:239]
    v_cvt_pk_bf16_f32 v111, v114, v115
    buffer_store_dwordx4 v[108:111], v240, s[32:35], 0 offen sc1
    v_cvt_pk_bf16_f32 v112, v116, v117
    s_waitcnt lgkmcnt(6)
    v_mfma_f32_32x32x16_bf16 v[176:191], v[60:63], v[68:71], v[176:191]
    ds_read_b128 v[92:95], v8 offset:0
    ds_read_b64_tr_b16 v[100:101], v9 offset:12288
    v_cvt_pk_bf16_f32 v113, v118, v119
    v_cvt_pk_bf16_f32 v114, v120, v121
    v_mfma_f32_32x32x16_bf16 v[192:207], v[64:67], v[68:71], v[192:207]
    ds_read_b64_tr_b16 v[102:103], v9 offset:13312
    ds_read_b128 v[96:99], v8 offset:4096
    v_cvt_pk_bf16_f32 v115, v122, v123
    buffer_store_dwordx4 v[112:115], v242, s[32:35], 0 offen sc1
    v_cvt_pk_bf16_f32 v124, v124, v125
    v_cvt_pk_bf16_f32 v125, v126, v127
    v_mfma_f32_32x32x16_bf16 v[208:223], v[60:63], v[72:75], v[208:223]
    ds_read_b64_tr_b16 v[104:105], v10 offset:12288
    ds_read_b64_tr_b16 v[106:107], v10 offset:13312
    v_cvt_pk_bf16_f32 v126, v128, v129
    v_cvt_pk_bf16_f32 v127, v130, v131
    buffer_store_dwordx4 v[124:127], v241, s[32:35], 0 offen sc1
    v_mfma_f32_32x32x16_bf16 v[224:239], v[64:67], v[72:75], v[224:239]
    v_cvt_pk_bf16_f32 v128, v132, v133
    v_cvt_pk_bf16_f32 v129, v134, v135
    s_add_u32 s13, s13, 1
    s_cmp_eq_u32 s13, 3
    s_cselect_b32 s14, 4294901760, s15
    s_cselect_b32 s13, 0, s13
    v_add_u32 v5, s14, v5
    v_add_u32 v6, s14, v6
    v_add_u32 v7, s14, v7
    v_add_u32 v8, s14, v8
    v_add_u32 v9, s14, v9
    v_add_u32 v10, s14, v10
    s_add_u32 s12, s12, 1
    s_waitcnt lgkmcnt(6)
    v_mfma_f32_32x32x16_bf16 v[176:191], v[76:79], v[84:87], v[176:191]
    v_cvt_pk_bf16_f32 v130, v136, v137
    v_cvt_pk_bf16_f32 v131, v138, v139
    buffer_store_dwordx4 v[128:131], v243, s[32:35], 0 offen sc1
    s_waitcnt lgkmcnt(0)
    s_barrier
    ds_read_b128 v[44:47], v5 offset:0
    ds_read_b64_tr_b16 v[52:53], v9 offset:0
    v_mfma_f32_32x32x16_bf16 v[192:207], v[80:83], v[84:87], v[192:207]
    ds_read_b64_tr_b16 v[54:55], v9 offset:1024
    ds_read_b128 v[48:51], v5 offset:4096
    v_cvt_pk_bf16_f32 v140, v140, v141
    v_cvt_pk_bf16_f32 v141, v142, v143
    v_cvt_pk_bf16_f32 v142, v144, v145
    v_mfma_f32_32x32x16_bf16 v[208:223], v[76:79], v[88:91], v[208:223]
    ds_read_b64_tr_b16 v[56:57], v10 offset:0
    ds_read_b64_tr_b16 v[58:59], v10 offset:1024
    v_cvt_pk_bf16_f32 v143, v146, v147
    buffer_store_dwordx4 v[140:143], v244, s[32:35], 0 offen sc1
    v_cvt_pk_bf16_f32 v144, v148, v149
    v_mfma_f32_32x32x16_bf16 v[224:239], v[80:83], v[88:91], v[224:239]
    ds_read_b128 v[60:63], v6 offset:0
    ds_read_b64_tr_b16 v[68:69], v9 offset:4096
    v_cvt_pk_bf16_f32 v145, v150, v151
    v_cvt_pk_bf16_f32 v146, v152, v153
    v_mfma_f32_32x32x16_bf16 v[176:191], v[92:95], v[100:103], v[176:191]
    ds_read_b64_tr_b16 v[70:71], v9 offset:5120
    ds_read_b128 v[64:67], v6 offset:4096
    v_cvt_pk_bf16_f32 v147, v154, v155
    buffer_store_dwordx4 v[144:147], v246, s[32:35], 0 offen sc1
    v_cvt_pk_bf16_f32 v156, v156, v157
    v_cvt_pk_bf16_f32 v157, v158, v159
    v_mfma_f32_32x32x16_bf16 v[192:207], v[96:99], v[100:103], v[192:207]
    ds_read_b64_tr_b16 v[72:73], v10 offset:4096
    ds_read_b64_tr_b16 v[74:75], v10 offset:5120
    v_cvt_pk_bf16_f32 v158, v160, v161
    v_cvt_pk_bf16_f32 v159, v162, v163
    buffer_store_dwordx4 v[156:159], v245, s[32:35], 0 offen sc1
    v_mfma_f32_32x32x16_bf16 v[208:223], v[92:95], v[104:107], v[208:223]
    v_cvt_pk_bf16_f32 v160, v164, v165
    v_cvt_pk_bf16_f32 v161, v166, v167
    v_mfma_f32_32x32x16_bf16 v[224:239], v[96:99], v[104:107], v[224:239]
    v_cvt_pk_bf16_f32 v162, v168, v169
    v_cvt_pk_bf16_f32 v163, v170, v171
    buffer_store_dwordx4 v[160:163], v247, s[32:35], 0 offen sc1
    s_waitcnt lgkmcnt(6)
    v_mfma_f32_32x32x16_bf16 v[176:191], v[44:47], v[52:55], v[176:191]
    ds_read_b128 v[76:79], v7 offset:0
    ds_read_b64_tr_b16 v[84:85], v9 offset:8192
    v_mfma_f32_32x32x16_bf16 v[192:207], v[48:51], v[52:55], v[192:207]
    ds_read_b64_tr_b16 v[86:87], v9 offset:9216
    ds_read_b128 v[80:83], v7 offset:4096
    v_mov_b64 v[136:137], v[16:17]
    v_mov_b64 v[138:139], v[16:17]
    v_mfma_f32_32x32x16_bf16 v[208:223], v[44:47], v[56:59], v[208:223]
    ds_read_b64_tr_b16 v[88:89], v10 offset:8192
    ds_read_b64_tr_b16 v[90:91], v10 offset:9216
    v_mov_b64 v[140:141], v[16:17]
    v_mfma_f32_32x32x16_bf16 v[224:239], v[48:51], v[56:59], v[224:239]
    v_mov_b64 v[142:143], v[16:17]
    s_waitcnt lgkmcnt(6)
    v_mfma_f32_32x32x16_bf16 v[176:191], v[60:63], v[68:71], v[176:191]
    ds_read_b128 v[92:95], v8 offset:0
    ds_read_b64_tr_b16 v[100:101], v9 offset:12288
    v_mov_b64 v[144:145], v[16:17]
    v_mov_b64 v[146:147], v[16:17]
    v_mfma_f32_32x32x16_bf16 v[192:207], v[64:67], v[68:71], v[192:207]
    ds_read_b64_tr_b16 v[102:103], v9 offset:13312
    ds_read_b128 v[96:99], v8 offset:4096
    v_mov_b64 v[148:149], v[16:17]
    v_mfma_f32_32x32x16_bf16 v[208:223], v[60:63], v[72:75], v[208:223]
    ds_read_b64_tr_b16 v[104:105], v10 offset:12288
    ds_read_b64_tr_b16 v[106:107], v10 offset:13312
    v_mov_b64 v[150:151], v[16:17]
    v_mfma_f32_32x32x16_bf16 v[224:239], v[64:67], v[72:75], v[224:239]
    v_mov_b64 v[152:153], v[16:17]
    s_add_u32 s13, s13, 1
    s_cmp_eq_u32 s13, 3
    s_cselect_b32 s14, 4294901760, s15
    s_cselect_b32 s13, 0, s13
    v_add_u32 v5, s14, v5
    v_add_u32 v6, s14, v6
    v_add_u32 v7, s14, v7
    v_add_u32 v8, s14, v8
    v_add_u32 v9, s14, v9
    v_add_u32 v10, s14, v10
    s_add_u32 s12, s12, 1
    s_waitcnt lgkmcnt(6)
    v_mfma_f32_32x32x16_bf16 v[176:191], v[76:79], v[84:87], v[176:191]
    v_mov_b64 v[154:155], v[16:17]
    v_mov_b64 v[156:157], v[16:17]
    s_waitcnt lgkmcnt(0)
    s_barrier
    ds_read_b128 v[44:47], v5 offset:0
    ds_read_b64_tr_b16 v[52:53], v9 offset:0
    v_mfma_f32_32x32x16_bf16 v[192:207], v[80:83], v[84:87], v[192:207]
    ds_read_b64_tr_b16 v[54:55], v9 offset:1024
    ds_read_b128 v[48:51], v5 offset:4096
    v_mov_b64 v[158:159], v[16:17]
    v_mfma_f32_32x32x16_bf16 v[208:223], v[76:79], v[88:91], v[208:223]
    ds_read_b64_tr_b16 v[56:57], v10 offset:0
    ds_read_b64_tr_b16 v[58:59], v10 offset:1024
    v_mov_b64 v[160:161], v[16:17]
    v_mfma_f32_32x32x16_bf16 v[224:239], v[80:83], v[88:91], v[224:239]
    ds_read_b128 v[60:63], v6 offset:0
    ds_read_b64_tr_b16 v[68:69], v9 offset:4096
    v_mov_b64 v[162:163], v[16:17]
    v_mfma_f32_32x32x16_bf16 v[176:191], v[92:95], v[100:103], v[176:191]
    ds_read_b64_tr_b16 v[70:71], v9 offset:5120
    ds_read_b128 v[64:67], v6 offset:4096
    v_mov_b64 v[164:165], v[16:17]
    v_mov_b64 v[166:167], v[16:17]
    v_mfma_f32_32x32x16_bf16 v[192:207], v[96:99], v[100:103], v[192:207]
    ds_read_b64_tr_b16 v[72:73], v10 offset:4096
    ds_read_b64_tr_b16 v[74:75], v10 offset:5120
    v_mov_b64 v[168:169], 0
    v_mfma_f32_32x32x16_bf16 v[208:223], v[92:95], v[104:107], v[208:223]
    v_mov_b32 v170, 0
    v_mfma_f32_32x32x16_bf16 v[224:239], v[96:99], v[104:107], v[224:239]
    s_load_dwordx2 s[78:79], s[18:19], 0
L_gb_v:
    s_waitcnt lgkmcnt(6)
    v_mfma_f32_32x32x16_bf16 v[176:191], v[44:47], v[52:55], v[176:191]
    ds_read_b128 v[76:79], v7 offset:0
    ds_read_b64_tr_b16 v[84:85], v9 offset:8192
    v_mfma_f32_32x32x16_bf16 v[192:207], v[48:51], v[52:55], v[192:207]
    ds_read_b64_tr_b16 v[86:87], v9 offset:9216
    ds_read_b128 v[80:83], v7 offset:4096
    v_mfma_f32_32x32x16_bf16 v[208:223], v[44:47], v[56:59], v[208:223]
    ds_read_b64_tr_b16 v[88:89], v10 offset:8192
    ds_read_b64_tr_b16 v[90:91], v10 offset:9216
    v_mfma_f32_32x32x16_bf16 v[224:239], v[48:51], v[56:59], v[224:239]
    s_waitcnt lgkmcnt(6)
    v_mfma_f32_32x32x16_bf16 v[176:191], v[60:63], v[68:71], v[176:191]
    ds_read_b128 v[92:95], v8 offset:0
    ds_read_b64_tr_b16 v[100:101], v9 offset:12288
    v_mfma_f32_32x32x16_bf16 v[192:207], v[64:67], v[68:71], v[192:207]
    ds_read_b64_tr_b16 v[102:103], v9 offset:13312
    ds_read_b128 v[96:99], v8 offset:4096
    v_mfma_f32_32x32x16_bf16 v[208:223], v[60:63], v[72:75], v[208:223]
    ds_read_b64_tr_b16 v[104:105], v10 offset:12288
    ds_read_b64_tr_b16 v[106:107], v10 offset:13312
    v_mfma_f32_32x32x16_bf16 v[224:239], v[64:67], v[72:75], v[224:239]
    s_add_u32 s13, s13, 1
    s_cmp_eq_u32 s13, 3
    s_cselect_b32 s14, 4294901760, s15
    s_cselect_b32 s13, 0, s13
    v_add_u32 v5, s14, v5
    v_add_u32 v6, s14, v6
    v_add_u32 v7, s14, v7
    v_add_u32 v8, s14, v8
    v_add_u32 v9, s14, v9
    v_add_u32 v10, s14, v10
    s_add_u32 s12, s12, 1
    s_cmp_eq_u32 s12, 20
    s_cbranch_scc1 L_ge_v
    s_waitcnt lgkmcnt(6)
    v_mfma_f32_32x32x16_bf16 v[176:191], v[76:79], v[84:87], v[176:191]
    s_cmp_lt_u32 s12, 14
    s_cbranch_scc1 L_gw_v
    s_waitcnt vmcnt(0)
L_gw_v:
    s_bitcmp1_b32 s29, s12
    s_waitcnt lgkmcnt(0)
    s_barrier
    s_cbranch_scc1 L_gh
L_ghr_v:
    ds_read_b128 v[44:47], v5 offset:0
    ds_read_b64_tr_b16 v[52:53], v9 offset:0
    v_mfma_f32_32x32x16_bf16 v[192:207], v[80:83], v[84:87], v[192:207]
    ds_read_b64_tr_b16 v[54:55], v9 offset:1024
    ds_read_b128 v[48:51], v5 offset:4096
    v_mfma_f32_32x32x16_bf16 v[208:223], v[76:79], v[88:91], v[208:223]
    ds_read_b64_tr_b16 v[56:57], v10 offset:0
    ds_read_b64_tr_b16 v[58:59], v10 offset:1024
    v_mfma_f32_32x32x16_bf16 v[224:239], v[80:83], v[88:91], v[224:239]
    ds_read_b128 v[60:63], v6 offset:0
    ds_read_b64_tr_b16 v[68:69], v9 offset:4096
    v_mfma_f32_32x32x16_bf16 v[176:191], v[92:95], v[100:103], v[176:191]
    ds_read_b64_tr_b16 v[70:71], v9 offset:5120
    ds_read_b128 v[64:67], v6 offset:4096
    v_mfma_f32_32x32x16_bf16 v[192:207], v[96:99], v[100:103], v[192:207]
    ds_read_b64_tr_b16 v[72:73], v10 offset:4096
    ds_read_b64_tr_b16 v[74:75], v10 offset:5120
    v_mfma_f32_32x32x16_bf16 v[208:223], v[92:95], v[104:107], v[208:223]
    v_mfma_f32_32x32x16_bf16 v[224:239], v[96:99], v[104:107], v[224:239]
    s_branch L_gb_v
L_ge_v:
    s_waitcnt lgkmcnt(0)
    v_mfma_f32_32x32x16_bf16 v[176:191], v[76:79], v[84:87], v[176:191]
    v_mfma_f32_32x32x16_bf16 v[192:207], v[80:83], v[84:87], v[192:207]
    v_mfma_f32_32x32x16_bf16 v[176:191], v[92:95], v[100:103], v[176:191]
    v_mfma_f32_32x32x16_bf16 v[192:207], v[96:99], v[100:103], v[192:207]
    v_mfma_f32_32x32x16_bf16 v[208:223], v[76:79], v[88:91], v[208:223]
    v_mfma_f32_32x32x16_bf16 v[224:239], v[80:83], v[88:91], v[224:239]
    s_nop 7
    s_nop 1
    v_cvt_pk_bf16_f32 v176, v176, v177
    v_cvt_pk_bf16_f32 v177, v178, v179
    v_mfma_f32_32x32x16_bf16 v[208:223], v[92:95], v[104:107], v[208:223]
    v_cvt_pk_bf16_f32 v178, v180, v181
    v_cvt_pk_bf16_f32 v179, v182, v183
    v_cvt_pk_bf16_f32 v180, v184, v185
    v_cvt_pk_bf16_f32 v181, v186, v187
    v_mfma_f32_32x32x16_bf16 v[224:239], v[96:99], v[104:107], v[224:239]
    v_cvt_pk_bf16_f32 v182, v188, v189
    v_cvt_pk_bf16_f32 v183, v190, v191
    v_cvt_pk_bf16_f32 v192, v192, v193
    v_cvt_pk_bf16_f32 v193, v194, v195
    v_cvt_pk_bf16_f32 v194, v196, v197
    v_cvt_pk_bf16_f32 v195, v198, v199
    v_cvt_pk_bf16_f32 v196, v200, v201
    v_cvt_pk_bf16_f32 v197, v202, v203
    v_cvt_pk_bf16_f32 v198, v204, v205
    v_cvt_pk_bf16_f32 v199, v206, v207
    s_nop 3
    v_cvt_pk_bf16_f32 v208, v208, v209
    v_cvt_pk_bf16_f32 v209, v210, v211
    v_cvt_pk_bf16_f32 v210, v212, v213
    v_cvt_pk_bf16_f32 v211, v214, v215
    v_cvt_pk_bf16_f32 v212, v216, v217
    v_cvt_pk_bf16_f32 v213, v218, v219
    v_cvt_pk_bf16_f32 v214, v220, v221
    v_cvt_pk_bf16_f32 v215, v222, v223
    v_cvt_pk_bf16_f32 v224, v224, v225
    v_cvt_pk_bf16_f32 v225, v226, v227
    v_cvt_pk_bf16_f32 v226, v228, v229
    v_cvt_pk_bf16_f32 v227, v230, v231
    v_cvt_pk_bf16_f32 v228, v232, v233
    v_cvt_pk_bf16_f32 v229, v234, v235
    v_cvt_pk_bf16_f32 v230, v236, v237
    v_cvt_pk_bf16_f32 v231, v238, v239
L_gfin:
    s_waitcnt lgkmcnt(0)
    s_cmp_lg_u64 s[78:79], 0
    s_cbranch_scc1 L_gn2_done
    v_mov_b32 v170, 0
    s_mov_b32 s72, 0x4000
L_gn2:
    global_load_dwordx2 v[172:173], v170, s[18:19] sc1
    s_sub_u32 s72, s72, 1
    s_waitcnt vmcnt(0)
    v_readfirstlane_b32 s78, v172
    v_readfirstlane_b32 s79, v173
    s_cmp_eq_u32 s72, 0
    s_cbranch_scc1 L_gn2_done
    s_sleep 8
    s_cmp_eq_u64 s[78:79], 0
    s_cbranch_scc1 L_gn2
L_gn2_done:
    s_waitcnt vmcnt(0)
    s_branch L_attn
L_attn:
    s_mov_b64 exec, s[64:65]
    v_mov_b64 v[28:29], v[20:21]
    s_mov_b64 exec, s[66:67]
    v_mov_b64 v[30:31], v[20:21]
    s_mov_b64 exec, -1
    s_barrier
    s_setprio 1
    ds_read_b64 v[124:125], v3 offset:0
    ds_read_b128 v[116:119], v2 offset:0
    ds_read_b128 v[120:123], v2 offset:1024
    s_mov_b64 exec, s[68:69]
    ds_read_b128 v[136:139], v4 offset:0
    ds_read_b128 v[140:143], v4 offset:640
    ds_read_b128 v[144:147], v4 offset:1280
    ds_read_b128 v[148:151], v4 offset:1920
    s_mov_b64 exec, -1
    v_mov_b64 v[84:85], 0
    v_mov_b64 v[86:87], 0
    v_mov_b64 v[88:89], 0
    v_mov_b64 v[90:91], 0
    v_mov_b64 v[92:93], 0
    v_mov_b64 v[94:95], 0
    v_mov_b64 v[96:97], 0
    v_mov_b64 v[98:99], 0
    v_mov_b64 v[48:49], 0
    v_mov_b64 v[50:51], 0
    s_waitcnt lgkmcnt(4)
    v_mfma_f32_32x32x8_bf16 v[52:67], v[124:125], v[28:29], 0
    v_mfma_f32_32x32x16_bf16 v[52:67], v[116:119], v[24:27], v[52:67]
    s_nop 7
    s_nop 3
    v_max3_f32 v16, v52, v53, v54
    v_max3_f32 v17, v55, v56, v57
    v_max3_f32 v18, v58, v59, v60
    v_max3_f32 v19, v61, v62, v63
    v_max3_f32 v16, v16, v64, v65
    v_max3_f32 v17, v17, v66, v67
    v_max3_f32 v16, v16, v18, v19
    v_max_f32 v16, v16, v17
    v_mov_b32 v17, v16
    s_nop 1
    v_permlane32_swap_b32 v16, v17
    s_nop 1
    v_max_f32 v16, v16, v17
    v_sub_f32 v16, 0xc27c0000, v16
    v_cvt_pk_bf16_f32 v168, v16, v16
    s_nop 1
    v_mfma_f32_32x32x8_bf16 v[100:115], v[42:43], v[168:169], 0
    v_mfma_f32_32x32x8_bf16 v[52:67], v[42:43], v[168:169], v[52:67]
    s_mov_b32 s54, 1
    s_nop 7
    ds_read_b64 v[134:135], v3 offset:5120
    ds_read_b128 v[126:129], v2 offset:5120
    ds_read_b128 v[130:133], v2 offset:6144
    v_mfma_f32_32x32x8_bf16 v[68:83], v[124:125], v[30:31], v[100:115]
    v_exp_f32 v52, v52
    v_exp_f32 v53, v53
    v_exp_f32 v54, v54
    v_exp_f32 v55, v55
    v_exp_f32 v56, v56
    v_mfma_f32_32x32x16_bf16 v[84:99], v[164:167], v[48:51], v[84:99]
    v_exp_f32 v57, v57
    v_exp_f32 v58, v58
    v_exp_f32 v59, v59
    v_cvt_pk_bf16_f32 v44, v52, v53
    v_cvt_pk_bf16_f32 v45, v54, v55
    v_cvt_pk_bf16_f32 v46, v56, v57
    v_cvt_pk_bf16_f32 v47, v58, v59
    v_mfma_f32_32x32x16_bf16 v[68:83], v[120:123], v[24:27], v[68:83]
    s_mov_b32 m0, s55
    s_add_u32 s48, s55, s63
    buffer_load_dwordx4 v1, s[32:35], s48 offen sc1 lds
    s_add_u32 s55, s55, 8192
    s_mov_b32 m0, s55
    s_add_u32 s48, s55, s63
    buffer_load_dwordx4 v1, s[32:35], s48 offen sc1 lds
    s_add_u32 s55, s55, 8192
    s_mov_b32 m0, s55
    s_add_u32 s48, s55, s63
    buffer_load_dwordx4 v1, s[32:35], s48 offen sc1 lds
    s_add_u32 s55, s55, 8192
    v_exp_f32 v60, v60
    v_exp_f32 v61, v61
    v_exp_f32 v62, v62
    v_exp_f32 v63, v63
    v_exp_f32 v64, v64
    s_waitcnt lgkmcnt(3)
    v_mfma_f32_32x32x16_bf16 v[84:99], v[136:139], v[44:47], v[84:99]
    v_exp_f32 v65, v65
    v_exp_f32 v66, v66
    v_exp_f32 v67, v67
    v_cvt_pk_bf16_f32 v48, v60, v61
    v_cvt_pk_bf16_f32 v49, v62, v63
    v_cvt_pk_bf16_f32 v50, v64, v65
    v_cvt_pk_bf16_f32 v51, v66, v67
    s_mov_b64 exec, s[68:69]
    ds_read_b128 v[152:155], v4 offset:5120
    ds_read_b128 v[156:159], v4 offset:5760
    ds_read_b128 v[160:163], v4 offset:6400
    ds_read_b128 v[164:167], v4 offset:7040
    s_mov_b64 exec, -1
    s_waitcnt lgkmcnt(4)
    v_mfma_f32_32x32x8_bf16 v[52:67], v[134:135], v[28:29], v[100:115]
    v_exp_f32 v68, v68
    v_exp_f32 v69, v69
    v_exp_f32 v70, v70
    v_exp_f32 v71, v71
    v_exp_f32 v72, v72
    v_mfma_f32_32x32x16_bf16 v[84:99], v[140:143], v[48:51], v[84:99]
    v_exp_f32 v73, v73
    v_exp_f32 v74, v74
    v_exp_f32 v75, v75
    v_cvt_pk_bf16_f32 v44, v68, v69
    v_cvt_pk_bf16_f32 v45, v70, v71
    v_cvt_pk_bf16_f32 v46, v72, v73
    v_cvt_pk_bf16_f32 v47, v74, v75
    v_mfma_f32_32x32x16_bf16 v[52:67], v[126:129], v[24:27], v[52:67]
    s_mov_b32 m0, s55
    s_add_u32 s48, s55, s63
    buffer_load_dwordx4 v1, s[32:35], s48 offen sc1 lds
    s_add_u32 s55, s55, 8192
    s_mov_b32 m0, s55
    s_add_u32 s48, s55, s63
    buffer_load_dwordx4 v1, s[32:35], s48 offen sc1 lds
    s_add_u32 s55, s55, 8192
    s_mov_b32 m0, s55
    s_add_u32 s48, s55, s63
    buffer_load_dwordx4 v1, s[32:35], s48 offen sc1 lds
    s_add_u32 s55, s55, 8192
    v_exp_f32 v76, v76
    v_exp_f32 v77, v77
    v_exp_f32 v78, v78
    v_exp_f32 v79, v79
    v_exp_f32 v80, v80
    v_mfma_f32_32x32x16_bf16 v[84:99], v[144:147], v[44:47], v[84:99]
    v_exp_f32 v81, v81
    v_exp_f32 v82, v82
    v_exp_f32 v83, v83
    v_cvt_pk_bf16_f32 v48, v76, v77
    v_cvt_pk_bf16_f32 v49, v78, v79
    v_cvt_pk_bf16_f32 v50, v80, v81
    v_cvt_pk_bf16_f32 v51, v82, v83
    ds_read_b64 v[124:125], v3 offset:10240
    ds_read_b128 v[116:119], v2 offset:10240
    ds_read_b128 v[120:123], v2 offset:11264
    v_mfma_f32_32x32x8_bf16 v[68:83], v[134:135], v[30:31], v[100:115]
    v_exp_f32 v52, v52
    v_exp_f32 v53, v53
    v_exp_f32 v54, v54
    v_exp_f32 v55, v55
    v_exp_f32 v56, v56
    v_mfma_f32_32x32x16_bf16 v[84:99], v[148:151], v[48:51], v[84:99]
    v_exp_f32 v57, v57
    v_exp_f32 v58, v58
    v_exp_f32 v59, v59
    v_cvt_pk_bf16_f32 v44, v52, v53
    v_cvt_pk_bf16_f32 v45, v54, v55
    v_cvt_pk_bf16_f32 v46, v56, v57
    v_cvt_pk_bf16_f32 v47, v58, v59
    v_mfma_f32_32x32x16_bf16 v[68:83], v[130:133], v[24:27], v[68:83]
    s_mov_b32 m0, s55
    s_add_u32 s48, s55, s63
    buffer_load_dwordx4 v1, s[32:35], s48 offen sc1 lds
    s_add_u32 s55, s55, 8192
    s_mov_b32 m0, s55
    s_add_u32 s48, s55, s63
    buffer_load_dwordx4 v1, s[32:35], s48 offen sc1 lds
    s_add_u32 s55, s55, 8192
    s_mov_b32 m0, s55
    s_add_u32 s48, s55, s63
    buffer_load_dwordx4 v1, s[32:35], s48 offen sc1 lds
    s_add_u32 s55, s55, 8192
    v_exp_f32 v60, v60
    v_exp_f32 v61, v61
    v_exp_f32 v62, v62
    v_exp_f32 v63, v63
    v_exp_f32 v64, v64
    s_waitcnt lgkmcnt(3)
    v_mfma_f32_32x32x16_bf16 v[84:99], v[152:155], v[44:47], v[84:99]
    v_exp_f32 v65, v65
    v_exp_f32 v66, v66
    v_exp_f32 v67, v67
    v_cvt_pk_bf16_f32 v48, v60, v61
    v_cvt_pk_bf16_f32 v49, v62, v63
    v_cvt_pk_bf16_f32 v50, v64, v65
    v_cvt_pk_bf16_f32 v51, v66, v67
    s_mov_b64 exec, s[68:69]
    ds_read_b128 v[136:139], v4 offset:10240
    ds_read_b128 v[140:143], v4 offset:10880
    ds_read_b128 v[144:147], v4 offset:11520
    ds_read_b128 v[148:151], v4 offset:12160
    s_mov_b64 exec, -1
    s_waitcnt lgkmcnt(4)
    v_mfma_f32_32x32x8_bf16 v[52:67], v[124:125], v[28:29], v[100:115]
    v_exp_f32 v68, v68
    v_exp_f32 v69, v69
    v_exp_f32 v70, v70
    v_exp_f32 v71, v71
    v_exp_f32 v72, v72
    v_mfma_f32_32x32x16_bf16 v[84:99], v[156:159], v[48:51], v[84:99]
    v_exp_f32 v73, v73
    v_exp_f32 v74, v74
    v_exp_f32 v75, v75
    v_cvt_pk_bf16_f32 v44, v68, v69
    v_cvt_pk_bf16_f32 v45, v70, v71
    v_cvt_pk_bf16_f32 v46, v72, v73
    v_cvt_pk_bf16_f32 v47, v74, v75
    v_mfma_f32_32x32x16_bf16 v[52:67], v[116:119], v[24:27], v[52:67]
    s_mov_b32 m0, s55
    s_add_u32 s48, s55, s63
    buffer_load_dwordx4 v1, s[32:35], s48 offen sc1 lds
    s_add_u32 s55, s55, 8192
    s_mov_b32 m0, s55
    s_add_u32 s48, s55, s63
    buffer_load_dwordx4 v1, s[32:35], s48 offen sc1 lds
    s_add_u32 s55, s55, 8192
    s_mov_b32 m0, s55
    s_add_u32 s48, s55, s63
    buffer_load_dwordx4 v1, s[32:35], s48 offen sc1 lds
    s_add_u32 s55, s55, 8192
    v_exp_f32 v76, v76
    v_exp_f32 v77, v77
    v_exp_f32 v78, v78
    v_exp_f32 v79, v79
    v_exp_f32 v80, v80
    v_mfma_f32_32x32x16_bf16 v[84:99], v[160:163], v[44:47], v[84:99]
    v_exp_f32 v81, v81
    v_exp_f32 v82, v82
    v_exp_f32 v83, v83
    v_cvt_pk_bf16_f32 v48, v76, v77
    v_cvt_pk_bf16_f32 v49, v78, v79
    v_cvt_pk_bf16_f32 v50, v80, v81
    v_cvt_pk_bf16_f32 v51, v82, v83
    ds_read_b64 v[134:135], v3 offset:15360
    ds_read_b128 v[126:129], v2 offset:15360
    ds_read_b128 v[130:133], v2 offset:16384
    v_mfma_f32_32x32x8_bf16 v[68:83], v[124:125], v[30:31], v[100:115]
    v_exp_f32 v52, v52
    v_exp_f32 v53, v53
    v_exp_f32 v54, v54
    v_exp_f32 v55, v55
    v_exp_f32 v56, v56
    v_mfma_f32_32x32x16_bf16 v[84:99], v[164:167], v[48:51], v[84:99]
    v_exp_f32 v57, v57
    v_exp_f32 v58, v58
    v_exp_f32 v59, v59
    v_cvt_pk_bf16_f32 v44, v52, v53
    v_cvt_pk_bf16_f32 v45, v54, v55
    v_cvt_pk_bf16_f32 v46, v56, v57
    v_cvt_pk_bf16_f32 v47, v58, v59
    v_mfma_f32_32x32x16_bf16 v[68:83], v[120:123], v[24:27], v[68:83]
    v_exp_f32 v60, v60
    v_exp_f32 v61, v61
    v_exp_f32 v62, v62
    v_exp_f32 v63, v63
    v_exp_f32 v64, v64
    s_waitcnt lgkmcnt(3)
    v_mfma_f32_32x32x16_bf16 v[84:99], v[136:139], v[44:47], v[84:99]
    v_exp_f32 v65, v65
    v_exp_f32 v66, v66
    v_exp_f32 v67, v67
    v_cvt_pk_bf16_f32 v48, v60, v61
    v_cvt_pk_bf16_f32 v49, v62, v63
    v_cvt_pk_bf16_f32 v50, v64, v65
    v_cvt_pk_bf16_f32 v51, v66, v67
    s_mov_b64 exec, s[68:69]
    ds_read_b128 v[152:155], v4 offset:15360
    ds_read_b128 v[156:159], v4 offset:16000
    ds_read_b128 v[160:163], v4 offset:16640
    ds_read_b128 v[164:167], v4 offset:17280
    s_mov_b64 exec, -1
    s_waitcnt lgkmcnt(4)
    v_mfma_f32_32x32x8_bf16 v[52:67], v[134:135], v[28:29], v[100:115]
    v_exp_f32 v68, v68
    v_exp_f32 v69, v69
    v_exp_f32 v70, v70
    v_exp_f32 v71, v71
    v_exp_f32 v72, v72
    v_mfma_f32_32x32x16_bf16 v[84:99], v[140:143], v[48:51], v[84:99]
    v_exp_f32 v73, v73
    v_exp_f32 v74, v74
    v_exp_f32 v75, v75
    v_cvt_pk_bf16_f32 v44, v68, v69
    v_cvt_pk_bf16_f32 v45, v70, v71
    v_cvt_pk_bf16_f32 v46, v72, v73
    v_cvt_pk_bf16_f32 v47, v74, v75
    v_mfma_f32_32x32x16_bf16 v[52:67], v[126:129], v[24:27], v[52:67]
    v_exp_f32 v76, v76
    v_exp_f32 v77, v77
    v_exp_f32 v78, v78
    v_exp_f32 v79, v79
    v_exp_f32 v80, v80
    v_mfma_f32_32x32x16_bf16 v[84:99], v[144:147], v[44:47], v[84:99]
    v_exp_f32 v81, v81
    v_exp_f32 v82, v82
    v_exp_f32 v83, v83
    v_cvt_pk_bf16_f32 v48, v76, v77
    v_cvt_pk_bf16_f32 v49, v78, v79
    v_cvt_pk_bf16_f32 v50, v80, v81
    v_cvt_pk_bf16_f32 v51, v82, v83
    ds_read_b64 v[124:125], v3 offset:20480
    ds_read_b128 v[116:119], v2 offset:20480
    ds_read_b128 v[120:123], v2 offset:21504
    v_mfma_f32_32x32x8_bf16 v[68:83], v[134:135], v[30:31], v[100:115]
    v_exp_f32 v52, v52
    v_exp_f32 v53, v53
    v_exp_f32 v54, v54
    v_exp_f32 v55, v55
    v_exp_f32 v56, v56
    v_mfma_f32_32x32x16_bf16 v[84:99], v[148:151], v[48:51], v[84:99]
    v_exp_f32 v57, v57
    v_exp_f32 v58, v58
    v_exp_f32 v59, v59
    v_cvt_pk_bf16_f32 v44, v52, v53
    v_cvt_pk_bf16_f32 v45, v54, v55
    v_cvt_pk_bf16_f32 v46, v56, v57
    v_cvt_pk_bf16_f32 v47, v58, v59
    v_mfma_f32_32x32x16_bf16 v[68:83], v[130:133], v[24:27], v[68:83]
    v_add_u32 v2, s59, v2
    v_add_u32 v3, s59, v3
    v_exp_f32 v60, v60
    v_exp_f32 v61, v61
    v_exp_f32 v62, v62
    v_exp_f32 v63, v63
    v_exp_f32 v64, v64
    s_waitcnt lgkmcnt(3)
    v_mfma_f32_32x32x16_bf16 v[84:99], v[152:155], v[44:47], v[84:99]
    v_exp_f32 v65, v65
    v_exp_f32 v66, v66
    v_exp_f32 v67, v67
    v_cvt_pk_bf16_f32 v48, v60, v61
    v_cvt_pk_bf16_f32 v49, v62, v63
    v_cvt_pk_bf16_f32 v50, v64, v65
    v_cvt_pk_bf16_f32 v51, v66, v67
    s_mov_b64 exec, s[68:69]
    ds_read_b128 v[136:139], v4 offset:20480
    ds_read_b128 v[140:143], v4 offset:21120
    ds_read_b128 v[144:147], v4 offset:21760
    ds_read_b128 v[148:151], v4 offset:22400
    s_mov_b64 exec, -1
    s_waitcnt lgkmcnt(4)
    v_mfma_f32_32x32x8_bf16 v[52:67], v[124:125], v[28:29], v[100:115]
    v_exp_f32 v68, v68
    v_exp_f32 v69, v69
    v_exp_f32 v70, v70
    v_exp_f32 v71, v71
    v_exp_f32 v72, v72
    v_mfma_f32_32x32x16_bf16 v[84:99], v[156:159], v[48:51], v[84:99]
    v_exp_f32 v73, v73
    v_exp_f32 v74, v74
    v_exp_f32 v75, v75
    v_cvt_pk_bf16_f32 v44, v68, v69
    v_cvt_pk_bf16_f32 v45, v70, v71
    v_cvt_pk_bf16_f32 v46, v72, v73
    v_cvt_pk_bf16_f32 v47, v74, v75
    v_mfma_f32_32x32x16_bf16 v[52:67], v[116:119], v[24:27], v[52:67]
    v_add_u32 v4, s59, v4
    v_exp_f32 v76, v76
    v_exp_f32 v77, v77
    v_exp_f32 v78, v78
    v_exp_f32 v79, v79
    v_exp_f32 v80, v80
    v_mfma_f32_32x32x16_bf16 v[84:99], v[160:163], v[44:47], v[84:99]
    v_exp_f32 v81, v81
    v_exp_f32 v82, v82
    v_exp_f32 v83, v83
    v_cvt_pk_bf16_f32 v48, v76, v77
    v_cvt_pk_bf16_f32 v49, v78, v79
    v_cvt_pk_bf16_f32 v50, v80, v81
    v_cvt_pk_bf16_f32 v51, v82, v83
    v_lshlrev_b32 v16, 2, v0
    v_mov_b32 v17, 0
    s_waitcnt vmcnt(0)
    s_barrier
    s_mov_b64 exec, 0xffff
    ds_write_b32 v16, v17
    s_mov_b64 exec, -1
    v_mov_b64 v[16:17], -1
    v_mov_b64 v[18:19], -1
    s_mov_b32 s48, 16777216
    s_waitcnt lgkmcnt(0)
    s_barrier
L_fill:
    buffer_store_dwordx4 v[16:19], v14, s[32:35], s48 offen sc1
    s_mov_b64 exec, s[64:65]
    buffer_store_dwordx2 v[16:17], v15, s[32:35], s48 offen sc1
    s_mov_b64 exec, -1
    s_cmp_ge_u32 s40, 4
    s_cbranch_scc1 L_aloop0
    s_max_u32 s48, s48, 19234816
    s_add_u32 s48, s48, 163840
    s_cmp_le_u32 s48, 19562496
    s_cbranch_scc1 L_fill
    s_cmp_eq_u32 s28, 0
    s_cbranch_scc1 L_aloop0
    buffer_store_dwordx4 v[176:179], v240, s[32:35], s26 offen sc1
    buffer_store_dwordx4 v[180:183], v242, s[32:35], s26 offen sc1
    buffer_store_dwordx4 v[192:195], v241, s[32:35], s26 offen sc1
    buffer_store_dwordx4 v[196:199], v243, s[32:35], s26 offen sc1
L_aloop0:
L_aloop:
    ds_read_b64 v[134:135], v3 offset:5120
    ds_read_b128 v[126:129], v2 offset:5120
    ds_read_b128 v[130:133], v2 offset:6144
    v_mfma_f32_32x32x8_bf16 v[68:83], v[124:125], v[30:31], v[100:115]
    v_exp_f32 v52, v52
    v_exp_f32 v53, v53
    v_exp_f32 v54, v54
    v_exp_f32 v55, v55
    v_exp_f32 v56, v56
    v_mfma_f32_32x32x16_bf16 v[84:99], v[164:167], v[48:51], v[84:99]
    v_exp_f32 v57, v57
    v_exp_f32 v58, v58
    v_exp_f32 v59, v59
    v_cvt_pk_bf16_f32 v44, v52, v53
    v_cvt_pk_bf16_f32 v45, v54, v55
    v_cvt_pk_bf16_f32 v46, v56, v57
    v_cvt_pk_bf16_f32 v47, v58, v59
    v_mfma_f32_32x32x16_bf16 v[68:83], v[120:123], v[24:27], v[68:83]
    v_exp_f32 v60, v60
    v_exp_f32 v61, v61
    v_exp_f32 v62, v62
    v_exp_f32 v63, v63
    v_exp_f32 v64, v64
    s_waitcnt lgkmcnt(3)
    v_mfma_f32_32x32x16_bf16 v[84:99], v[136:139], v[44:47], v[84:99]
    v_exp_f32 v65, v65
    v_exp_f32 v66, v66
    v_exp_f32 v67, v67
    v_cvt_pk_bf16_f32 v48, v60, v61
    v_cvt_pk_bf16_f32 v49, v62, v63
    v_cvt_pk_bf16_f32 v50, v64, v65
    v_cvt_pk_bf16_f32 v51, v66, v67
    s_mov_b64 exec, s[68:69]
    ds_read_b128 v[152:155], v4 offset:5120
    ds_read_b128 v[156:159], v4 offset:5760
    ds_read_b128 v[160:163], v4 offset:6400
    ds_read_b128 v[164:167], v4 offset:7040
    s_mov_b64 exec, -1
    s_waitcnt lgkmcnt(4)
    v_mfma_f32_32x32x8_bf16 v[52:67], v[134:135], v[28:29], v[100:115]
    v_exp_f32 v68, v68
    v_exp_f32 v69, v69
    v_exp_f32 v70, v70
    v_exp_f32 v71, v71
    v_exp_f32 v72, v72
    v_mfma_f32_32x32x16_bf16 v[84:99], v[140:143], v[48:51], v[84:99]
    v_exp_f32 v73, v73
    v_exp_f32 v74, v74
    v_exp_f32 v75, v75
    v_cvt_pk_bf16_f32 v44, v68, v69
    v_cvt_pk_bf16_f32 v45, v70, v71
    v_cvt_pk_bf16_f32 v46, v72, v73
    v_cvt_pk_bf16_f32 v47, v74, v75
    v_mfma_f32_32x32x16_bf16 v[52:67], v[126:129], v[24:27], v[52:67]
    v_exp_f32 v76, v76
    v_exp_f32 v77, v77
    v_exp_f32 v78, v78
    v_exp_f32 v79, v79
    v_exp_f32 v80, v80
    v_mfma_f32_32x32x16_bf16 v[84:99], v[144:147], v[44:47], v[84:99]
    v_exp_f32 v81, v81
    v_exp_f32 v82, v82
    v_exp_f32 v83, v83
    v_cvt_pk_bf16_f32 v48, v76, v77
    v_cvt_pk_bf16_f32 v49, v78, v79
    v_cvt_pk_bf16_f32 v50, v80, v81
    v_cvt_pk_bf16_f32 v51, v82, v83
    ds_read_b64 v[124:125], v3 offset:10240
    ds_read_b128 v[116:119], v2 offset:10240
    ds_read_b128 v[120:123], v2 offset:11264
    v_mfma_f32_32x32x8_bf16 v[68:83], v[134:135], v[30:31], v[100:115]
    v_exp_f32 v52, v52
    v_exp_f32 v53, v53
    v_exp_f32 v54, v54
    v_exp_f32 v55, v55
    v_exp_f32 v56, v56
    v_mfma_f32_32x32x16_bf16 v[84:99], v[148:151], v[48:51], v[84:99]
    v_exp_f32 v57, v57
    v_exp_f32 v58, v58
    v_exp_f32 v59, v59
    v_cvt_pk_bf16_f32 v44, v52, v53
    v_cvt_pk_bf16_f32 v45, v54, v55
    v_cvt_pk_bf16_f32 v46, v56, v57
    v_cvt_pk_bf16_f32 v47, v58, v59
    v_mfma_f32_32x32x16_bf16 v[68:83], v[130:133], v[24:27], v[68:83]
    v_exp_f32 v60, v60
    v_exp_f32 v61, v61
    v_exp_f32 v62, v62
    v_exp_f32 v63, v63
    v_exp_f32 v64, v64
    s_waitcnt lgkmcnt(3)
    v_mfma_f32_32x32x16_bf16 v[84:99], v[152:155], v[44:47], v[84:99]
    v_exp_f32 v65, v65
    v_exp_f32 v66, v66
    v_exp_f32 v67, v67
    v_cvt_pk_bf16_f32 v48, v60, v61
    v_cvt_pk_bf16_f32 v49, v62, v63
    v_cvt_pk_bf16_f32 v50, v64, v65
    v_cvt_pk_bf16_f32 v51, v66, v67
    s_mov_b64 exec, s[68:69]
    ds_read_b128 v[136:139], v4 offset:10240
    ds_read_b128 v[140:143], v4 offset:10880
    ds_read_b128 v[144:147], v4 offset:11520
    ds_read_b128 v[148:151], v4 offset:12160
    s_mov_b64 exec, -1
    s_waitcnt lgkmcnt(4)
    v_mfma_f32_32x32x8_bf16 v[52:67], v[124:125], v[28:29], v[100:115]
    v_exp_f32 v68, v68
    v_exp_f32 v69, v69
    v_exp_f32 v70, v70
    v_exp_f32 v71, v71
    v_exp_f32 v72, v72
    v_mfma_f32_32x32x16_bf16 v[84:99], v[156:159], v[48:51], v[84:99]
    v_exp_f32 v73, v73
    v_exp_f32 v74, v74
    v_exp_f32 v75, v75
    v_cvt_pk_bf16_f32 v44, v68, v69
    v_cvt_pk_bf16_f32 v45, v70, v71
    v_cvt_pk_bf16_f32 v46, v72, v73
    v_cvt_pk_bf16_f32 v47, v74, v75
    v_mfma_f32_32x32x16_bf16 v[52:67], v[116:119], v[24:27], v[52:67]
    v_exp_f32 v76, v76
    v_exp_f32 v77, v77
    v_exp_f32 v78, v78
    v_exp_f32 v79, v79
    v_exp_f32 v80, v80
    v_mfma_f32_32x32x16_bf16 v[84:99], v[160:163], v[44:47], v[84:99]
    v_exp_f32 v81, v81
    v_exp_f32 v82, v82
    v_exp_f32 v83, v83
    v_cvt_pk_bf16_f32 v48, v76, v77
    v_cvt_pk_bf16_f32 v49, v78, v79
    v_cvt_pk_bf16_f32 v50, v80, v81
    v_cvt_pk_bf16_f32 v51, v82, v83
    ds_read_b64 v[134:135], v3 offset:15360
    ds_read_b128 v[126:129], v2 offset:15360
    ds_read_b128 v[130:133], v2 offset:16384
    s_cmp_eq_u32 s54, s57
    s_cbranch_scc1 L_hm
L_hmr:
    v_mfma_f32_32x32x8_bf16 v[68:83], v[124:125], v[30:31], v[100:115]
    v_exp_f32 v52, v52
    v_exp_f32 v53, v53
    v_exp_f32 v54, v54
    v_exp_f32 v55, v55
    v_exp_f32 v56, v56
    v_mfma_f32_32x32x16_bf16 v[84:99], v[164:167], v[48:51], v[84:99]
    v_exp_f32 v57, v57
    v_exp_f32 v58, v58
    v_exp_f32 v59, v59
    v_cvt_pk_bf16_f32 v44, v52, v53
    v_cvt_pk_bf16_f32 v45, v54, v55
    v_cvt_pk_bf16_f32 v46, v56, v57
    v_cvt_pk_bf16_f32 v47, v58, v59
    v_mfma_f32_32x32x16_bf16 v[68:83], v[120:123], v[24:27], v[68:83]
    v_exp_f32 v60, v60
    v_exp_f32 v61, v61
    v_exp_f32 v62, v62
    v_exp_f32 v63, v63
    v_exp_f32 v64, v64
    s_waitcnt lgkmcnt(3)
    v_mfma_f32_32x32x16_bf16 v[84:99], v[136:139], v[44:47], v[84:99]
    v_exp_f32 v65, v65
    v_exp_f32 v66, v66
    v_exp_f32 v67, v67
    v_cvt_pk_bf16_f32 v48, v60, v61
    v_cvt_pk_bf16_f32 v49, v62, v63
    v_cvt_pk_bf16_f32 v50, v64, v65
    v_cvt_pk_bf16_f32 v51, v66, v67
    s_mov_b64 exec, s[68:69]
    ds_read_b128 v[152:155], v4 offset:15360
    ds_read_b128 v[156:159], v4 offset:16000
    ds_read_b128 v[160:163], v4 offset:16640
    ds_read_b128 v[164:167], v4 offset:17280
    s_mov_b64 exec, -1
    s_waitcnt lgkmcnt(4)
    v_mfma_f32_32x32x8_bf16 v[52:67], v[134:135], v[28:29], v[100:115]
    v_exp_f32 v68, v68
    v_exp_f32 v69, v69
    v_exp_f32 v70, v70
    v_exp_f32 v71, v71
    v_exp_f32 v72, v72
    v_mfma_f32_32x32x16_bf16 v[84:99], v[140:143], v[48:51], v[84:99]
    v_exp_f32 v73, v73
    v_exp_f32 v74, v74
    v_exp_f32 v75, v75
    v_cvt_pk_bf16_f32 v44, v68, v69
    v_cvt_pk_bf16_f32 v45, v70, v71
    v_cvt_pk_bf16_f32 v46, v72, v73
    v_cvt_pk_bf16_f32 v47, v74, v75
    v_mfma_f32_32x32x16_bf16 v[52:67], v[126:129], v[24:27], v[52:67]
    v_exp_f32 v76, v76
    v_exp_f32 v77, v77
    v_exp_f32 v78, v78
    v_exp_f32 v79, v79
    v_exp_f32 v80, v80
    v_mfma_f32_32x32x16_bf16 v[84:99], v[144:147], v[44:47], v[84:99]
    v_exp_f32 v81, v81
    v_exp_f32 v82, v82
    v_exp_f32 v83, v83
    v_cvt_pk_bf16_f32 v48, v76, v77
    v_cvt_pk_bf16_f32 v49, v78, v79
    v_cvt_pk_bf16_f32 v50, v80, v81
    v_cvt_pk_bf16_f32 v51, v82, v83
    ds_read_b64 v[124:125], v3 offset:20480
    ds_read_b128 v[116:119], v2 offset:20480
    ds_read_b128 v[120:123], v2 offset:21504
    v_mfma_f32_32x32x8_bf16 v[68:83], v[134:135], v[30:31], v[100:115]
    v_exp_f32 v52, v52
    v_exp_f32 v53, v53
    v_exp_f32 v54, v54
    v_exp_f32 v55, v55
    v_exp_f32 v56, v56
    v_mfma_f32_32x32x16_bf16 v[84:99], v[148:151], v[48:51], v[84:99]
    v_exp_f32 v57, v57
    v_exp_f32 v58, v58
    v_exp_f32 v59, v59
    v_cvt_pk_bf16_f32 v44, v52, v53
    v_cvt_pk_bf16_f32 v45, v54, v55
    v_cvt_pk_bf16_f32 v46, v56, v57
    v_cvt_pk_bf16_f32 v47, v58, v59
    v_mfma_f32_32x32x16_bf16 v[68:83], v[130:133], v[24:27], v[68:83]
    v_add_u32 v2, s59, v2
    v_add_u32 v3, s59, v3
    v_exp_f32 v60, v60
    v_exp_f32 v61, v61
    v_exp_f32 v62, v62
    v_exp_f32 v63, v63
    v_exp_f32 v64, v64
    s_waitcnt lgkmcnt(3)
    v_mfma_f32_32x32x16_bf16 v[84:99], v[152:155], v[44:47], v[84:99]
    v_exp_f32 v65, v65
    v_exp_f32 v66, v66
    v_exp_f32 v67, v67
    v_cvt_pk_bf16_f32 v48, v60, v61
    v_cvt_pk_bf16_f32 v49, v62, v63
    v_cvt_pk_bf16_f32 v50, v64, v65
    v_cvt_pk_bf16_f32 v51, v66, v67
    s_mov_b64 exec, s[68:69]
    ds_read_b128 v[136:139], v4 offset:20480
    ds_read_b128 v[140:143], v4 offset:21120
    ds_read_b128 v[144:147], v4 offset:21760
    ds_read_b128 v[148:151], v4 offset:22400
    s_mov_b64 exec, -1
    s_waitcnt lgkmcnt(4)
    v_mfma_f32_32x32x8_bf16 v[52:67], v[124:125], v[28:29], v[100:115]
    v_exp_f32 v68, v68
    v_exp_f32 v69, v69
    v_exp_f32 v70, v70
    v_exp_f32 v71, v71
    v_exp_f32 v72, v72
    v_mfma_f32_32x32x16_bf16 v[84:99], v[156:159], v[48:51], v[84:99]
    v_exp_f32 v73, v73
    v_exp_f32 v74, v74
    v_exp_f32 v75, v75
    v_cvt_pk_bf16_f32 v44, v68, v69
    v_cvt_pk_bf16_f32 v45, v70, v71
    v_cvt_pk_bf16_f32 v46, v72, v73
    v_cvt_pk_bf16_f32 v47, v74, v75
    v_mfma_f32_32x32x16_bf16 v[52:67], v[116:119], v[24:27], v[52:67]
    v_add_u32 v4, s59, v4
    v_exp_f32 v76, v76
    v_exp_f32 v77, v77
    v_exp_f32 v78, v78
    v_exp_f32 v79, v79
    v_exp_f32 v80, v80
    v_mfma_f32_32x32x16_bf16 v[84:99], v[160:163], v[44:47], v[84:99]
    v_exp_f32 v81, v81
    v_exp_f32 v82, v82
    v_exp_f32 v83, v83
    v_cvt_pk_bf16_f32 v48, v76, v77
    v_cvt_pk_bf16_f32 v49, v78, v79
    v_cvt_pk_bf16_f32 v50, v80, v81
    v_cvt_pk_bf16_f32 v51, v82, v83
    s_add_u32 s54, s54, 1
    s_bitcmp1_b32 s62, s54
    s_cbranch_scc1 L_hook
L_ahookr:
    s_cmp_lt_u32 s54, 8
    s_cbranch_scc1 L_aloop
    s_cmp_lt_u32 s40, 4
    s_cbranch_scc1 L_nofa
    v_lshlrev_b32 v4, 3, v0
    s_mov_b64 exec, 0xffff
    buffer_load_dwordx2 v[2:3], v4, s[32:35], s9 offen sc1
    s_mov_b64 exec, -1
L_nofa:
    v_mfma_f32_32x32x16_bf16 v[84:99], v[164:167], v[48:51], v[84:99]
    s_waitcnt lgkmcnt(0)
    s_nop 7
    s_nop 3
    v_rcp_f32 v16, v96
    v_mul_f32 v17, 0x4d800000, v96
    v_mul_f32 v18, 0x4d800000, v16
    v_mul_f32 v17, 0, v17
    v_mul_f32 v18, 0, v18
    v_fma_f32 v17, v84, 0, v17
    v_fma_f32 v18, v85, 0, v18
    v_fma_f32 v17, v86, 0, v17
    v_fma_f32 v18, v87, 0, v18
    v_fma_f32 v17, v88, 0, v17
    v_fma_f32 v18, v89, 0, v18
    v_fma_f32 v17, v90, 0, v17
    v_fma_f32 v18, v91, 0, v18
    v_fma_f32 v17, v92, 0, v17
    v_fma_f32 v18, v93, 0, v18
    v_fma_f32 v17, v94, 0, v17
    v_fma_f32 v18, v95, 0, v18
    v_cmp_u_f32 vcc, v17, v18
    s_mov_b32 s58, 0
    s_nop 3
    s_cbranch_vccnz L_fallback
L_fin0:
    v_mul_f32 v84, v16, v84
    v_mul_f32 v85, v16, v85
    v_mul_f32 v86, v16, v86
    v_mul_f32 v87, v16, v87
    v_mul_f32 v88, v16, v88
    v_mul_f32 v89, v16, v89
    v_mul_f32 v90, v16, v90
    v_mul_f32 v91, v16, v91
    v_mul_f32 v92, v16, v92
    v_mul_f32 v93, v16, v93
    v_mul_f32 v94, v16, v94
    v_mul_f32 v95, v16, v95
    v_cvt_pk_bf16_f32 v44, v84, v85
    v_cvt_pk_bf16_f32 v45, v86, v87
    v_cvt_pk_bf16_f32 v46, v88, v89
    v_cvt_pk_bf16_f32 v47, v90, v91
    v_cvt_pk_bf16_f32 v48, v92, v93
    v_cvt_pk_bf16_f32 v49, v94, v95
    s_mov_b32 s61, 16777216
    buffer_store_dwordx4 v[44:47], v14, s[32:35], s61 offen sc1
    s_mov_b64 exec, s[64:65]
    buffer_store_dwordx2 v[48:49], v15, s[32:35], s61 offen sc1
    s_mov_b64 exec, -1
    s_cmp_lt_u32 s40, 4
    s_cbranch_scc0 L_op
    s_waitcnt vmcnt(22)
    s_mov_b64 s[24:25], 3
    v_mov_b32 v16, 32
    v_mov_b32 v17, 1
    s_mov_b64 exec, 1
    ds_add_u32 v16, v17
    s_mov_b64 exec, -1
    s_mov_b32 s23, s40
L_bpass:
    s_mov_b32 s48, s23
    s_lshr_b32 s49, s48, 1
    s_mul_i32 s49, s49, 5120
    s_add_u32 s49, s49, 0xfffd8400
    s_and_b32 s48, s48, 1
    v_add_u32 v8, s49, v3
    s_lshl_b32 s50, s48, 10
    s_add_u32 s50, s50, s49
    v_add_u32 v5, s50, v2
    s_mul_i32 s50, s48, 1280
    s_add_u32 s50, s50, s49
    v_add_u32 v11, s50, v4
    s_add_u32 s48, s23, 1
    s_lshr_b32 s49, s48, 1
    s_mul_i32 s49, s49, 5120
    s_add_u32 s49, s49, 0xfffd8400
    s_and_b32 s48, s48, 1
    v_add_u32 v9, s49, v3
    s_lshl_b32 s50, s48, 10
    s_add_u32 s50, s50, s49
    v_add_u32 v6, s50, v2
    s_mul_i32 s50, s48, 1280
    s_add_u32 s50, s50, s49
    v_add_u32 v12, s50, v4
    s_cmp_eq_u32 s56, 0
    s_addc_u32 s48, s23, 7
    s_lshr_b32 s49, s48, 1
    s_mul_i32 s49, s49, 5120
    s_add_u32 s49, s49, 0xfffd8400
    s_and_b32 s48, s48, 1
    v_add_u32 v10, s49, v3
    s_lshl_b32 s50, s48, 10
    s_add_u32 s50, s50, s49
    v_add_u32 v7, s50, v2
    s_mul_i32 s50, s48, 1280
    s_add_u32 s50, s50, s49
    v_add_u32 v13, s50, v4
    s_cmp_eq_u32 s56, 0
    s_cselect_b32 s48, s70, 0
    v_mov_b32 v18, s48
    s_max_u32 s57, s23, 1
    s_add_u32 s57, s57, 1
    s_cmp_eq_u32 s46, 0
    s_cselect_b32 s57, s57, 99
    v_mov_b32 v20, s70
    v_mov_b32 v21, 0
    s_mov_b32 vcc_lo, 0xffffffff
    s_mov_b32 vcc_hi, 0xfffffff0
    v_cndmask_b32 v68, v20, v18, vcc
    v_cndmask_b32 v52, v18, v21, vcc
    s_mov_b32 vcc_lo, 0xfffffffe
    s_mov_b32 vcc_hi, 0xffffffe0
    v_cndmask_b32 v69, v20, v18, vcc
    v_cndmask_b32 v53, v18, v21, vcc
    s_mov_b32 vcc_lo, 0xfffffffc
    s_mov_b32 vcc_hi, 0xffffffc0
    v_cndmask_b32 v70, v20, v18, vcc
    v_cndmask_b32 v54, v18, v21, vcc
    s_mov_b32 vcc_lo, 0xfffffff8
    s_mov_b32 vcc_hi, 0xffffff80
    v_cndmask_b32 v71, v20, v18, vcc
    v_cndmask_b32 v55, v18, v21, vcc
    s_mov_b32 vcc_lo, 0xffffff00
    s_mov_b32 vcc_hi, 0xfffff000
    v_cndmask_b32 v72, v20, v18, vcc
    v_cndmask_b32 v56, v18, v21, vcc
    s_mov_b32 vcc_lo, 0xfffffe00
    s_mov_b32 vcc_hi, 0xffffe000
    v_cndmask_b32 v73, v20, v18, vcc
    v_cndmask_b32 v57, v18, v21, vcc
    s_mov_b32 vcc_lo, 0xfffffc00
    s_mov_b32 vcc_hi, 0xffffc000
    v_cndmask_b32 v74, v20, v18, vcc
    v_cndmask_b32 v58, v18, v21, vcc
    s_mov_b32 vcc_lo, 0xfffff800
    s_mov_b32 vcc_hi, 0xffff8000
    v_cndmask_b32 v75, v20, v18, vcc
    v_cndmask_b32 v59, v18, v21, vcc
    s_mov_b32 vcc_lo, 0xffff0000
    s_mov_b32 vcc_hi, 0xfff00000
    v_cndmask_b32 v76, v20, v18, vcc
    v_cndmask_b32 v60, v18, v21, vcc
    s_mov_b32 vcc_lo, 0xfffe0000
    s_mov_b32 vcc_hi, 0xffe00000
    v_cndmask_b32 v77, v20, v18, vcc
    v_cndmask_b32 v61, v18, v21, vcc
    s_mov_b32 vcc_lo, 0xfffc0000
    s_mov_b32 vcc_hi, 0xffc00000
    v_cndmask_b32 v78, v20, v18, vcc
    v_cndmask_b32 v62, v18, v21, vcc
    s_mov_b32 vcc_lo, 0xfff80000
    s_mov_b32 vcc_hi, 0xff800000
    v_cndmask_b32 v79, v20, v18, vcc
    v_cndmask_b32 v63, v18, v21, vcc
    s_mov_b32 vcc_lo, 0xff000000
    s_mov_b32 vcc_hi, 0xf0000000
    v_cndmask_b32 v80, v20, v18, vcc
    v_cndmask_b32 v64, v18, v21, vcc
    s_mov_b32 vcc_lo, 0xfe000000
    s_mov_b32 vcc_hi, 0xe0000000
    v_cndmask_b32 v81, v20, v18, vcc
    v_cndmask_b32 v65, v18, v21, vcc
    s_mov_b32 vcc_lo, 0xfc000000
    s_mov_b32 vcc_hi, 0xc0000000
    v_cndmask_b32 v82, v20, v18, vcc
    v_cndmask_b32 v66, v18, v21, vcc
    s_mov_b32 vcc_lo, 0xf8000000
    s_mov_b32 vcc_hi, 0x80000000
    v_cndmask_b32 v83, v20, v18, vcc
    v_cndmask_b32 v67, v18, v21, vcc
    v_mov_b64 v[36:37], 0
    v_mov_b64 v[38:39], 0
    s_bitcmp1_b32 s40, 0
    s_cselect_b64 exec, s[66:67], s[64:65]
    v_mov_b64 v[36:37], v[40:41]
    s_not_b64 exec, exec
    v_mov_b64 v[38:39], v[40:41]
    s_cmp_eq_u32 s56, 0
    s_cselect_b64 exec, s[64:65], exec
    s_not_b64 exec, exec
    v_mov_b64 v[40:41], 0
    s_mov_b64 exec, -1
    v_mov_b32 v16, 32
    s_mov_b32 s72, 0x40000
L_w8:
    ds_read_b32 v17, v16
    s_sub_u32 s72, s72, 1
    s_waitcnt lgkmcnt(0)
    v_readfirstlane_b32 s48, v17
    s_cbranch_scc1 L_w8_done
    s_cmp_ge_u32 s48, 4
    s_cbranch_scc1 L_w8_done
    s_sleep 1
    s_branch L_w8
L_w8_done:
    ds_read_b64 v[124:125], v10 offset:0
    ds_read_b128 v[116:119], v7 offset:0
    ds_read_b64 v[134:135], v8 offset:20480
    ds_read_b128 v[126:129], v5 offset:20480
    s_mov_b64 exec, s[68:69]
    ds_read_b128 v[136:139], v13 offset:0
    ds_read_b128 v[140:143], v13 offset:640
    s_mov_b64 exec, -1
    s_waitcnt lgkmcnt(4)
    v_mfma_f32_32x32x8_bf16 v[52:67], v[124:125], v[40:41], v[52:67]
    v_mfma_f32_32x32x16_bf16 v[52:67], v[116:119], v[32:35], v[52:67]
    s_nop 7
    s_nop 3
    v_max3_f32 v16, v52, v53, v54
    v_max3_f32 v17, v55, v56, v57
    v_max3_f32 v18, v58, v59, v60
    v_max3_f32 v19, v61, v62, v63
    v_max3_f32 v16, v16, v64, v65
    v_max3_f32 v17, v17, v66, v67
    v_max3_f32 v16, v16, v18, v19
    v_max_f32 v16, v16, v17
    v_mov_b32 v17, v16
    s_nop 1
    v_permlane32_swap_b32 v16, v17
    s_nop 1
    v_max_f32 v16, v16, v17
    v_sub_f32 v16, 0xc27c0000, v16
    v_cvt_pk_bf16_f32 v168, v16, v16
    s_nop 1
    v_mfma_f32_32x32x8_bf16 v[52:67], v[42:43], v[168:169], v[52:67]
    v_mfma_f32_32x32x8_bf16 v[100:115], v[42:43], v[168:169], 0
    v_mfma_f32_32x32x8_bf16 v[68:83], v[42:43], v[168:169], v[68:83]
    s_nop 7
    ds_read_b64 v[124:125], v8 offset:15360
    ds_read_b128 v[116:119], v5 offset:15360
    s_mov_b64 exec, s[68:69]
    ds_read_b128 v[144:147], v11 offset:20480
    ds_read_b128 v[148:151], v11 offset:21120
    s_mov_b64 exec, -1
    s_waitcnt lgkmcnt(6)
    v_mfma_f32_32x32x8_bf16 v[68:83], v[134:135], v[36:37], v[68:83]
    v_exp_f32 v52, v52
    v_exp_f32 v53, v53
    v_exp_f32 v54, v54
    v_exp_f32 v55, v55
    v_exp_f32 v56, v56
    v_exp_f32 v57, v57
    v_exp_f32 v58, v58
    v_exp_f32 v59, v59
    v_cvt_pk_bf16_f32 v44, v52, v53
    v_cvt_pk_bf16_f32 v45, v54, v55
    v_cvt_pk_bf16_f32 v46, v56, v57
    v_cvt_pk_bf16_f32 v47, v58, v59
    v_mfma_f32_32x32x16_bf16 v[68:83], v[126:129], v[32:35], v[68:83]
    v_exp_f32 v60, v60
    v_exp_f32 v61, v61
    v_exp_f32 v62, v62
    v_exp_f32 v63, v63
    v_exp_f32 v64, v64
    s_waitcnt lgkmcnt(4)
    v_mfma_f32_32x32x16_bf16 v[84:99], v[136:139], v[44:47], 0
    v_exp_f32 v65, v65
    v_exp_f32 v66, v66
    v_exp_f32 v67, v67
    v_cvt_pk_bf16_f32 v48, v60, v61
    v_cvt_pk_bf16_f32 v49, v62, v63
    v_cvt_pk_bf16_f32 v50, v64, v65
    v_cvt_pk_bf16_f32 v51, v66, v67
    ds_read_b64 v[134:135], v9 offset:10240
    ds_read_b128 v[126:129], v6 offset:10240
    s_mov_b64 exec, s[68:69]
    ds_read_b128 v[152:155], v11 offset:15360
    ds_read_b128 v[156:159], v11 offset:16000
    s_mov_b64 exec, -1
    s_cmp_eq_u32 s57, 2
    s_cbranch_scc1 L_lim2
L_limr2:
    s_waitcnt lgkmcnt(6)
    v_mfma_f32_32x32x8_bf16 v[52:67], v[124:125], v[36:37], v[100:115]
    v_exp_f32 v68, v68
    v_exp_f32 v69, v69
    v_exp_f32 v70, v70
    v_exp_f32 v71, v71
    v_exp_f32 v72, v72
    v_mfma_f32_32x32x16_bf16 v[84:99], v[140:143], v[48:51], v[84:99]
    v_exp_f32 v73, v73
    v_exp_f32 v74, v74
    v_exp_f32 v75, v75
    v_cvt_pk_bf16_f32 v44, v68, v69
    v_cvt_pk_bf16_f32 v45, v70, v71
    v_cvt_pk_bf16_f32 v46, v72, v73
    v_cvt_pk_bf16_f32 v47, v74, v75
    v_mfma_f32_32x32x16_bf16 v[52:67], v[116:119], v[32:35], v[52:67]
    v_exp_f32 v76, v76
    v_exp_f32 v77, v77
    v_exp_f32 v78, v78
    v_exp_f32 v79, v79
    v_exp_f32 v80, v80
    s_waitcnt lgkmcnt(4)
    v_mfma_f32_32x32x16_bf16 v[84:99], v[144:147], v[44:47], v[84:99]
    v_exp_f32 v81, v81
    v_exp_f32 v82, v82
    v_exp_f32 v83, v83
    v_cvt_pk_bf16_f32 v48, v76, v77
    v_cvt_pk_bf16_f32 v49, v78, v79
    v_cvt_pk_bf16_f32 v50, v80, v81
    v_cvt_pk_bf16_f32 v51, v82, v83
    ds_read_b64 v[124:125], v8 offset:10240
    ds_read_b128 v[116:119], v5 offset:10240
    s_mov_b64 exec, s[68:69]
    ds_read_b128 v[160:163], v12 offset:10240
    ds_read_b128 v[164:167], v12 offset:10880
    s_mov_b64 exec, -1
    s_cmp_eq_u32 s57, 3
    s_cbranch_scc1 L_lim3
L_limr3:
    s_waitcnt lgkmcnt(6)
    v_mfma_f32_32x32x8_bf16 v[68:83], v[134:135], v[38:39], v[100:115]
    v_exp_f32 v52, v52
    v_exp_f32 v53, v53
    v_exp_f32 v54, v54
    v_exp_f32 v55, v55
    v_exp_f32 v56, v56
    v_mfma_f32_32x32x16_bf16 v[84:99], v[148:151], v[48:51], v[84:99]
    v_exp_f32 v57, v57
    v_exp_f32 v58, v58
    v_exp_f32 v59, v59
    v_cvt_pk_bf16_f32 v44, v52, v53
    v_cvt_pk_bf16_f32 v45, v54, v55
    v_cvt_pk_bf16_f32 v46, v56, v57
    v_cvt_pk_bf16_f32 v47, v58, v59
    v_mfma_f32_32x32x16_bf16 v[68:83], v[126:129], v[32:35], v[68:83]
    v_exp_f32 v60, v60
    v_exp_f32 v61, v61
    v_exp_f32 v62, v62
    v_exp_f32 v63, v63
    v_exp_f32 v64, v64
    s_waitcnt lgkmcnt(4)
    v_mfma_f32_32x32x16_bf16 v[84:99], v[152:155], v[44:47], v[84:99]
    v_exp_f32 v65, v65
    v_exp_f32 v66, v66
    v_exp_f32 v67, v67
    v_cvt_pk_bf16_f32 v48, v60, v61
    v_cvt_pk_bf16_f32 v49, v62, v63
    v_cvt_pk_bf16_f32 v50, v64, v65
    v_cvt_pk_bf16_f32 v51, v66, v67
    ds_read_b64 v[134:135], v9 offset:5120
    ds_read_b128 v[126:129], v6 offset:5120
    s_mov_b64 exec, s[68:69]
    ds_read_b128 v[136:139], v11 offset:10240
    ds_read_b128 v[140:143], v11 offset:10880
    s_mov_b64 exec, -1
    s_cmp_eq_u32 s57, 4
    s_cbranch_scc1 L_lim4
L_limr4:
    s_waitcnt lgkmcnt(6)
    v_mfma_f32_32x32x8_bf16 v[52:67], v[124:125], v[36:37], v[100:115]
    v_exp_f32 v68, v68
    v_exp_f32 v69, v69
    v_exp_f32 v70, v70
    v_exp_f32 v71, v71
    v_exp_f32 v72, v72
    v_mfma_f32_32x32x16_bf16 v[84:99], v[156:159], v[48:51], v[84:99]
    v_exp_f32 v73, v73
    v_exp_f32 v74, v74
    v_exp_f32 v75, v75
    v_cvt_pk_bf16_f32 v44, v68, v69
    v_cvt_pk_bf16_f32 v45, v70, v71
    v_cvt_pk_bf16_f32 v46, v72, v73
    v_cvt_pk_bf16_f32 v47, v74, v75
    v_mfma_f32_32x32x16_bf16 v[52:67], v[116:119], v[32:35], v[52:67]
    v_exp_f32 v76, v76
    v_exp_f32 v77, v77
    v_exp_f32 v78, v78
    v_exp_f32 v79, v79
    v_exp_f32 v80, v80
    s_waitcnt lgkmcnt(4)
    v_mfma_f32_32x32x16_bf16 v[84:99], v[160:163], v[44:47], v[84:99]
    v_exp_f32 v81, v81
    v_exp_f32 v82, v82
    v_exp_f32 v83, v83
    v_cvt_pk_bf16_f32 v48, v76, v77
    v_cvt_pk_bf16_f32 v49, v78, v79
    v_cvt_pk_bf16_f32 v50, v80, v81
    v_cvt_pk_bf16_f32 v51, v82, v83
    ds_read_b64 v[124:125], v8 offset:5120
    ds_read_b128 v[116:119], v5 offset:5120
    s_mov_b64 exec, s[68:69]
    ds_read_b128 v[144:147], v12 offset:5120
    ds_read_b128 v[148:151], v12 offset:5760
    s_mov_b64 exec, -1
    s_cmp_eq_u32 s57, 5
    s_cbranch_scc1 L_lim5
L_limr5:
    s_waitcnt lgkmcnt(6)
    v_mfma_f32_32x32x8_bf16 v[68:83], v[134:135], v[38:39], v[100:115]
    v_exp_f32 v52, v52
    v_exp_f32 v53, v53
    v_exp_f32 v54, v54
    v_exp_f32 v55, v55
    v_exp_f32 v56, v56
    v_mfma_f32_32x32x16_bf16 v[84:99], v[164:167], v[48:51], v[84:99]
    v_exp_f32 v57, v57
    v_exp_f32 v58, v58
    v_exp_f32 v59, v59
    v_cvt_pk_bf16_f32 v44, v52, v53
    v_cvt_pk_bf16_f32 v45, v54, v55
    v_cvt_pk_bf16_f32 v46, v56, v57
    v_cvt_pk_bf16_f32 v47, v58, v59
    v_mfma_f32_32x32x16_bf16 v[68:83], v[126:129], v[32:35], v[68:83]
    s_waitcnt vmcnt(0)
    v_mov_b64 v[16:17], s[78:79]
    v_lshlrev_b32 v18, 16, v0
    s_mov_b64 exec, s[24:25]
    buffer_store_dwordx2 v[16:17], v18, s[32:35], s22 offen sc1
    s_mov_b64 exec, -1
    v_exp_f32 v60, v60
    v_exp_f32 v61, v61
    v_exp_f32 v62, v62
    v_exp_f32 v63, v63
    v_exp_f32 v64, v64
    s_waitcnt lgkmcnt(4)
    v_mfma_f32_32x32x16_bf16 v[84:99], v[136:139], v[44:47], v[84:99]
    v_exp_f32 v65, v65
    v_exp_f32 v66, v66
    v_exp_f32 v67, v67
    v_cvt_pk_bf16_f32 v48, v60, v61
    v_cvt_pk_bf16_f32 v49, v62, v63
    v_cvt_pk_bf16_f32 v50, v64, v65
    v_cvt_pk_bf16_f32 v51, v66, v67
    ds_read_b64 v[134:135], v9 offset:0
    ds_read_b128 v[126:129], v6 offset:0
    s_mov_b64 exec, s[68:69]
    ds_read_b128 v[152:155], v11 offset:5120
    ds_read_b128 v[156:159], v11 offset:5760
    s_mov_b64 exec, -1
    s_cmp_eq_u32 s57, 6
    s_cbranch_scc1 L_lim6
L_limr6:
    s_waitcnt lgkmcnt(6)
    v_mfma_f32_32x32x8_bf16 v[52:67], v[124:125], v[36:37], v[100:115]
    v_exp_f32 v68, v68
    v_exp_f32 v69, v69
    v_exp_f32 v70, v70
    v_exp_f32 v71, v71
    v_exp_f32 v72, v72
    v_mfma_f32_32x32x16_bf16 v[84:99], v[140:143], v[48:51], v[84:99]
    v_exp_f32 v73, v73
    v_exp_f32 v74, v74
    v_exp_f32 v75, v75
    v_cvt_pk_bf16_f32 v44, v68, v69
    v_cvt_pk_bf16_f32 v45, v70, v71
    v_cvt_pk_bf16_f32 v46, v72, v73
    v_cvt_pk_bf16_f32 v47, v74, v75
    v_mfma_f32_32x32x16_bf16 v[52:67], v[116:119], v[32:35], v[52:67]
    s_cmp_lt_u32 s23, 4
    s_cbranch_scc1 L_nofl
    v_lshlrev_b32 v4, 3, v0
    s_mov_b64 exec, 0xffff
    buffer_load_dwordx2 v[2:3], v4, s[32:35], s9 offen sc1
    s_mov_b64 exec, -1
L_nofl:
    v_exp_f32 v76, v76
    v_exp_f32 v77, v77
    v_exp_f32 v78, v78
    v_exp_f32 v79, v79
    v_exp_f32 v80, v80
    s_waitcnt lgkmcnt(4)
    v_mfma_f32_32x32x16_bf16 v[84:99], v[144:147], v[44:47], v[84:99]
    v_exp_f32 v81, v81
    v_exp_f32 v82, v82
    v_exp_f32 v83, v83
    v_cvt_pk_bf16_f32 v48, v76, v77
    v_cvt_pk_bf16_f32 v49, v78, v79
    v_cvt_pk_bf16_f32 v50, v80, v81
    v_cvt_pk_bf16_f32 v51, v82, v83
    ds_read_b64 v[124:125], v8 offset:0
    ds_read_b128 v[116:119], v5 offset:0
    s_mov_b64 exec, s[68:69]
    ds_read_b128 v[160:163], v12 offset:0
    ds_read_b128 v[164:167], v12 offset:640
    s_mov_b64 exec, -1
    s_cmp_eq_u32 s57, 7
    s_cbranch_scc1 L_lim7
L_limr7:
    s_waitcnt lgkmcnt(6)
    v_mfma_f32_32x32x8_bf16 v[68:83], v[134:135], v[38:39], v[100:115]
    v_exp_f32 v52, v52
    v_exp_f32 v53, v53
    v_exp_f32 v54, v54
    v_exp_f32 v55, v55
    v_exp_f32 v56, v56
    v_mfma_f32_32x32x16_bf16 v[84:99], v[148:151], v[48:51], v[84:99]
    v_exp_f32 v57, v57
    v_exp_f32 v58, v58
    v_exp_f32 v59, v59
    v_cvt_pk_bf16_f32 v44, v52, v53
    v_cvt_pk_bf16_f32 v45, v54, v55
    v_cvt_pk_bf16_f32 v46, v56, v57
    v_cvt_pk_bf16_f32 v47, v58, v59
    v_mfma_f32_32x32x16_bf16 v[68:83], v[126:129], v[32:35], v[68:83]
    s_mov_b32 vcc_lo, 0xffffffff
    s_mov_b32 vcc_hi, 0xfffffff0
    v_cndmask_b32 v100, v100, v20, vcc
    s_mov_b32 vcc_lo, 0xfffffffe
    s_mov_b32 vcc_hi, 0xffffffe0
    v_cndmask_b32 v101, v101, v20, vcc
    s_mov_b32 vcc_lo, 0xfffffffc
    s_mov_b32 vcc_hi, 0xffffffc0
    v_cndmask_b32 v102, v102, v20, vcc
    s_mov_b32 vcc_lo, 0xfffffff8
    s_mov_b32 vcc_hi, 0xffffff80
    v_cndmask_b32 v103, v103, v20, vcc
    s_mov_b32 vcc_lo, 0xffffff00
    s_mov_b32 vcc_hi, 0xfffff000
    v_cndmask_b32 v104, v104, v20, vcc
    s_mov_b32 vcc_lo, 0xfffffe00
    s_mov_b32 vcc_hi, 0xffffe000
    v_cndmask_b32 v105, v105, v20, vcc
    s_mov_b32 vcc_lo, 0xfffffc00
    s_mov_b32 vcc_hi, 0xffffc000
    v_cndmask_b32 v106, v106, v20, vcc
    s_mov_b32 vcc_lo, 0xfffff800
    s_mov_b32 vcc_hi, 0xffff8000
    v_cndmask_b32 v107, v107, v20, vcc
    s_mov_b32 vcc_lo, 0xffff0000
    s_mov_b32 vcc_hi, 0xfff00000
    v_cndmask_b32 v108, v108, v20, vcc
    s_mov_b32 vcc_lo, 0xfffe0000
    s_mov_b32 vcc_hi, 0xffe00000
    v_cndmask_b32 v109, v109, v20, vcc
    s_mov_b32 vcc_lo, 0xfffc0000
    s_mov_b32 vcc_hi, 0xffc00000
    v_cndmask_b32 v110, v110, v20, vcc
    s_mov_b32 vcc_lo, 0xfff80000
    s_mov_b32 vcc_hi, 0xff800000
    v_cndmask_b32 v111, v111, v20, vcc
    s_mov_b32 vcc_lo, 0xff000000
    s_mov_b32 vcc_hi, 0xf0000000
    v_cndmask_b32 v112, v112, v20, vcc
    s_mov_b32 vcc_lo, 0xfe000000
    s_mov_b32 vcc_hi, 0xe0000000
    v_cndmask_b32 v113, v113, v20, vcc
    s_mov_b32 vcc_lo, 0xfc000000
    s_mov_b32 vcc_hi, 0xc0000000
    v_cndmask_b32 v114, v114, v20, vcc
    s_mov_b32 vcc_lo, 0xf8000000
    s_mov_b32 vcc_hi, 0x80000000
    v_cndmask_b32 v115, v115, v20, vcc
    v_exp_f32 v60, v60
    v_exp_f32 v61, v61
    v_exp_f32 v62, v62
    v_exp_f32 v63, v63
    v_exp_f32 v64, v64
    s_waitcnt lgkmcnt(4)
    v_mfma_f32_32x32x16_bf16 v[84:99], v[152:155], v[44:47], v[84:99]
    v_exp_f32 v65, v65
    v_exp_f32 v66, v66
    v_exp_f32 v67, v67
    v_cvt_pk_bf16_f32 v48, v60, v61
    v_cvt_pk_bf16_f32 v49, v62, v63
    v_cvt_pk_bf16_f32 v50, v64, v65
    v_cvt_pk_bf16_f32 v51, v66, v67
    s_mov_b64 exec, s[68:69]
    ds_read_b128 v[136:139], v11 offset:0
    ds_read_b128 v[140:143], v11 offset:640
    s_mov_b64 exec, -1
    s_cmp_eq_u32 s57, 8
    s_cbranch_scc1 L_lim8
L_limr8:
    s_waitcnt lgkmcnt(4)
    v_mfma_f32_32x32x8_bf16 v[52:67], v[124:125], v[36:37], v[100:115]
    v_exp_f32 v68, v68
    v_exp_f32 v69, v69
    v_exp_f32 v70, v70
    v_exp_f32 v71, v71
    v_exp_f32 v72, v72
    v_mfma_f32_32x32x16_bf16 v[84:99], v[156:159], v[48:51], v[84:99]
    v_exp_f32 v73, v73
    v_exp_f32 v74, v74
    v_exp_f32 v75, v75
    v_cvt_pk_bf16_f32 v44, v68, v69
    v_cvt_pk_bf16_f32 v45, v70, v71
    v_cvt_pk_bf16_f32 v46, v72, v73
    v_cvt_pk_bf16_f32 v47, v74, v75
    v_mfma_f32_32x32x16_bf16 v[52:67], v[116:119], v[32:35], v[52:67]
    v_exp_f32 v76, v76
    v_exp_f32 v77, v77
    v_exp_f32 v78, v78
    v_exp_f32 v79, v79
    v_exp_f32 v80, v80
    s_waitcnt lgkmcnt(2)
    v_mfma_f32_32x32x16_bf16 v[84:99], v[160:163], v[44:47], v[84:99]
    v_exp_f32 v81, v81
    v_exp_f32 v82, v82
    v_exp_f32 v83, v83
    v_cvt_pk_bf16_f32 v48, v76, v77
    v_cvt_pk_bf16_f32 v49, v78, v79
    v_cvt_pk_bf16_f32 v50, v80, v81
    v_cvt_pk_bf16_f32 v51, v82, v83
    v_exp_f32 v52, v52
    v_exp_f32 v53, v53
    v_exp_f32 v54, v54
    v_exp_f32 v55, v55
    v_exp_f32 v56, v56
    v_mfma_f32_32x32x16_bf16 v[84:99], v[164:167], v[48:51], v[84:99]
    v_exp_f32 v57, v57
    v_exp_f32 v58, v58
    v_exp_f32 v59, v59
    v_cvt_pk_bf16_f32 v44, v52, v53
    v_cvt_pk_bf16_f32 v45, v54, v55
    v_cvt_pk_bf16_f32 v46, v56, v57
    v_cvt_pk_bf16_f32 v47, v58, v59
    v_exp_f32 v60, v60
    v_exp_f32 v61, v61
    v_exp_f32 v62, v62
    v_exp_f32 v63, v63
    v_exp_f32 v64, v64
    s_waitcnt lgkmcnt(0)
    v_mfma_f32_32x32x16_bf16 v[84:99], v[136:139], v[44:47], v[84:99]
    v_exp_f32 v65, v65
    v_exp_f32 v66, v66
    v_exp_f32 v67, v67
    v_cvt_pk_bf16_f32 v48, v60, v61
    v_cvt_pk_bf16_f32 v49, v62, v63
    v_cvt_pk_bf16_f32 v50, v64, v65
    v_cvt_pk_bf16_f32 v51, v66, v67
    s_nop 1
    v_mfma_f32_32x32x16_bf16 v[84:99], v[140:143], v[48:51], v[84:99]
    s_nop 7
    s_nop 3
    v_rcp_f32 v16, v96
    v_mul_f32 v17, 0x4d800000, v96
    v_mul_f32 v18, 0x4d800000, v16
    v_mul_f32 v17, 0, v17
    v_mul_f32 v18, 0, v18
    v_fma_f32 v17, v84, 0, v17
    v_fma_f32 v18, v85, 0, v18
    v_fma_f32 v17, v86, 0, v17
    v_fma_f32 v18, v87, 0, v18
    v_fma_f32 v17, v88, 0, v17
    v_fma_f32 v18, v89, 0, v18
    v_fma_f32 v17, v90, 0, v17
    v_fma_f32 v18, v91, 0, v18
    v_fma_f32 v17, v92, 0, v17
    v_fma_f32 v18, v93, 0, v18
    v_fma_f32 v17, v94, 0, v17
    v_fma_f32 v18, v95, 0, v18
    v_cmp_u_f32 vcc, v17, v18
    s_mov_b32 s58, 1
    s_nop 3
    s_cbranch_vccnz L_fallback
L_fin1:
    v_mul_f32 v84, v16, v84
    v_mul_f32 v85, v16, v85
    v_mul_f32 v86, v16, v86
    v_mul_f32 v87, v16, v87
    v_mul_f32 v88, v16, v88
    v_mul_f32 v89, v16, v89
    v_mul_f32 v90, v16, v90
    v_mul_f32 v91, v16, v91
    v_mul_f32 v92, v16, v92
    v_mul_f32 v93, v16, v93
    v_mul_f32 v94, v16, v94
    v_mul_f32 v95, v16, v95
    v_cvt_pk_bf16_f32 v44, v84, v85
    v_cvt_pk_bf16_f32 v45, v86, v87
    v_cvt_pk_bf16_f32 v46, v88, v89
    v_cvt_pk_bf16_f32 v47, v90, v91
    v_cvt_pk_bf16_f32 v48, v92, v93
    v_cvt_pk_bf16_f32 v49, v94, v95
    s_mov_b32 s61, 19398656
    buffer_store_dwordx4 v[44:47], v14, s[32:35], s61 offen sc1
    s_mov_b64 exec, s[64:65]
    buffer_store_dwordx2 v[48:49], v15, s[32:35], s61 offen sc1
    s_mov_b64 exec, -1
    s_cmp_ge_u32 s23, 4
    s_cbranch_scc1 L_opb
    s_add_u32 s22, s22, 66560
    s_mov_b64 s[24:25], 1
    s_add_u32 s23, s23, 4
    s_add_u32 s56, s56, 4
    s_add_u32 s60, s60, 5120
    v_add_u32 v14, 163840, v14
    v_add_u32 v15, 163840, v15
    v_mov_b64 v[32:33], v[170:171]
    v_mov_b64 v[34:35], v[172:173]
    v_mov_b64 v[40:41], v[174:175]
    s_branch L_bpass
L_opb:
L_op:
    s_setprio 2
    buffer_load_dwordx4 v[16:19], v1, s[32:35], s77 offen offset:0 sc1
    buffer_load_dwordx4 v[20:23], v1, s[32:35], s77 offen offset:1024 sc1
    buffer_load_dwordx4 v[24:27], v1, s[32:35], s77 offen offset:2048 sc1
    buffer_load_dwordx4 v[28:31], v1, s[32:35], s77 offen offset:3072 sc1
    s_add_u32 s77, s77, 4096
    buffer_load_dwordx4 v[32:35], v1, s[32:35], s77 offen offset:0 sc1
    s_mov_b32 s56, 0x11111
    s_mov_b32 s58, 0x4000
    v_add_u32 v5, s10, v1
    s_cmp_lt_u32 s40, 4
    s_cselect_b32 s48, 12, 60
    s_cselect_b32 s59, 12, 24
    v_mov_b32 v6, s48
    v_mov_b32 v7, 1
    s_mov_b64 exec, 1
    ds_add_u32 v6, v7
    s_mov_b64 exec, -1
    s_waitcnt vmcnt(7)
    s_branch L_oeval
L_osleep:
    s_setprio 0
    s_sleep 2
    s_mov_b64 exec, 0xffff
    buffer_load_dwordx2 v[2:3], v4, s[32:35], s9 offen sc1
    s_mov_b64 exec, -1
L_onext:
    s_waitcnt vmcnt(0)
L_oeval:
    s_mov_b64 exec, 0xffff
    v_cmp_eq_u64 vcc, s[78:79], v[2:3]
    s_mov_b64 exec, -1
    s_sub_u32 s58, s58, 1
    s_cmp_lt_i32 s58, 0
    s_cselect_b32 s50, 0xffff, vcc_lo
    s_cselect_b64 s[14:15], 0, -1
    s_lshr_b32 s48, s50, 1
    s_and_b32 s48, s48, s50
    s_lshr_b32 s49, s48, 2
    s_and_b32 s48, s48, s49
    s_add_u32 s50, s50, 1
    s_and_b32 s50, s50, 0x10000
    s_or_b32 s48, s48, s50
    s_and_b32 s57, s48, s56
    s_cbranch_scc0 L_osleep
    s_setprio 2
    s_bitcmp0_b32 s57, 0
    s_cbranch_scc1 L_ol0
    buffer_load_dwordx4 v[36:39], v1, s[32:35], s4 offen offset:0 sc1
    buffer_load_dwordx4 v[40:43], v1, s[32:35], s5 offen offset:0 sc1
    buffer_load_dwordx4 v[44:47], v1, s[32:35], s6 offen offset:0 sc1
    buffer_load_dwordx4 v[48:51], v1, s[32:35], s7 offen offset:0 sc1
L_ol0:
    s_bitcmp0_b32 s57, 4
    s_cbranch_scc1 L_ol1
    buffer_load_dwordx4 v[52:55], v1, s[32:35], s4 offen offset:1024 sc1
    buffer_load_dwordx4 v[56:59], v1, s[32:35], s5 offen offset:1024 sc1
    buffer_load_dwordx4 v[60:63], v1, s[32:35], s6 offen offset:1024 sc1
    buffer_load_dwordx4 v[64:67], v1, s[32:35], s7 offen offset:1024 sc1
L_ol1:
    s_bitcmp0_b32 s57, 8
    s_cbranch_scc1 L_ol2
    buffer_load_dwordx4 v[68:71], v1, s[32:35], s4 offen offset:2048 sc1
    buffer_load_dwordx4 v[72:75], v1, s[32:35], s5 offen offset:2048 sc1
    buffer_load_dwordx4 v[76:79], v1, s[32:35], s6 offen offset:2048 sc1
    buffer_load_dwordx4 v[80:83], v1, s[32:35], s7 offen offset:2048 sc1
L_ol2:
    s_bitcmp0_b32 s57, 12
    s_cbranch_scc1 L_ol3
    buffer_load_dwordx4 v[84:87], v1, s[32:35], s4 offen offset:3072 sc1
    buffer_load_dwordx4 v[88:91], v1, s[32:35], s5 offen offset:3072 sc1
    buffer_load_dwordx4 v[92:95], v1, s[32:35], s6 offen offset:3072 sc1
    buffer_load_dwordx4 v[96:99], v1, s[32:35], s7 offen offset:3072 sc1
L_ol3:
    s_bitcmp0_b32 s57, 16
    s_cbranch_scc1 L_ol4
    buffer_load_dwordx4 v[100:103], v5, s[32:35], s4 offen offset:0 sc1
    buffer_load_dwordx4 v[104:107], v5, s[32:35], s5 offen offset:0 sc1
    buffer_load_dwordx4 v[108:111], v5, s[32:35], s6 offen offset:0 sc1
    buffer_load_dwordx4 v[112:115], v5, s[32:35], s7 offen offset:0 sc1
L_ol4:
    s_mov_b64 exec, 0xffff
    buffer_load_dwordx2 v[2:3], v4, s[32:35], s9 offen sc1
    s_mov_b64 exec, -1
    s_mov_b32 s16, s57
    s_cmp_lt_u32 s40, 4
    s_setprio 0
    s_cbranch_scc1 L_omq
    s_setprio 1
L_omq:
    s_cmp_eq_u32 s17, 0
    s_cbranch_scc1 L_onz
    s_mov_b32 s17, 0
    v_mov_b64 v[116:117], 0
    v_mov_b64 v[118:119], 0
    v_mov_b64 v[120:121], 0
    v_mov_b64 v[122:123], 0
    v_mov_b64 v[124:125], 0
    v_mov_b64 v[126:127], 0
    v_mov_b64 v[128:129], 0
    v_mov_b64 v[130:131], 0
    v_mov_b64 v[132:133], 0
    v_mov_b64 v[134:135], 0
    v_mov_b64 v[136:137], 0
    v_mov_b64 v[138:139], 0
    v_mov_b64 v[140:141], 0
    v_mov_b64 v[142:143], 0
    v_mov_b64 v[144:145], 0
    v_mov_b64 v[146:147], 0
    v_mov_b64 v[148:149], 0
    v_mov_b64 v[150:151], 0
    v_mov_b64 v[152:153], 0
    v_mov_b64 v[154:155], 0
    v_mov_b64 v[156:157], 0
    v_mov_b64 v[158:159], 0
    v_mov_b64 v[160:161], 0
    v_mov_b64 v[162:163], 0
    v_mov_b64 v[164:165], 0
    v_mov_b64 v[166:167], 0
    v_mov_b64 v[168:169], 0
    v_mov_b64 v[170:171], 0
    v_mov_b64 v[172:173], 0
    v_mov_b64 v[174:175], 0
L_onz:
    s_bitcmp0_b32 s57, 0
    s_cbranch_scc1 L_ob0
    s_lshr_b32 s48, s57, 1
    s_bcnt1_i32_b32 s48, s48
    s_waitcnt vmcnt(17)
    s_cmp_ge_u32 s48, 4
    s_cbranch_scc1 L_owf
    s_waitcnt vmcnt(13)
    s_cmp_ge_u32 s48, 3
    s_cbranch_scc1 L_owf
    s_waitcnt vmcnt(9)
    s_cmp_ge_u32 s48, 2
    s_cbranch_scc1 L_owf
    s_waitcnt vmcnt(5)
    s_cmp_ge_u32 s48, 1
    s_cbranch_scc1 L_owf
    s_waitcnt vmcnt(1)
L_owf:
    v_max3_u32 v13, v36, v37, v38
    v_max3_u32 v14, v39, v40, v41
    v_max3_u32 v15, v42, v43, v44
    v_max3_u32 v13, v13, v45, v46
    v_max3_u32 v14, v14, v47, v48
    v_max3_u32 v15, v15, v49, v50
    v_max3_u32 v13, v13, v14, v51
    v_max_u32 v13, v13, v15
    v_cmp_eq_u32 vcc, -1, v13
    s_nop 0
    s_and_b64 vcc, vcc, s[14:15]
    s_cselect_b32 s48, 0x1, 0
    s_andn2_b32 s16, s16, s48
L_oa0:
    s_bitcmp0_b32 s16, 0
    s_cbranch_scc1 L_ob0
    v_mfma_f32_16x16x32_bf16 v[116:119], v[176:179], v[36:39], v[116:119]
    v_mfma_f32_16x16x32_bf16 v[120:123], v[180:183], v[36:39], v[120:123]
    v_mfma_f32_16x16x32_bf16 v[124:127], v[184:187], v[36:39], v[124:127]
    v_mfma_f32_16x16x32_bf16 v[128:131], v[188:191], v[36:39], v[128:131]
    v_mfma_f32_16x16x32_bf16 v[132:135], v[192:195], v[36:39], v[132:135]
    v_mfma_f32_16x16x32_bf16 v[136:139], v[176:179], v[40:43], v[136:139]
    v_mfma_f32_16x16x32_bf16 v[140:143], v[180:183], v[40:43], v[140:143]
    v_mfma_f32_16x16x32_bf16 v[144:147], v[184:187], v[40:43], v[144:147]
    v_mfma_f32_16x16x32_bf16 v[148:151], v[188:191], v[40:43], v[148:151]
    v_mfma_f32_16x16x32_bf16 v[152:155], v[192:195], v[40:43], v[152:155]
    s_lshr_b32 s48, s57, 5
    s_bcnt1_i32_b32 s48, s48
    s_waitcnt vmcnt(13)
    s_cmp_ge_u32 s48, 3
    s_cbranch_scc1 L_owa0
    s_waitcnt vmcnt(9)
    s_cmp_ge_u32 s48, 2
    s_cbranch_scc1 L_owa0
    s_waitcnt vmcnt(5)
    s_cmp_ge_u32 s48, 1
    s_cbranch_scc1 L_owa0
    s_waitcnt vmcnt(1)
L_owa0:
    v_mfma_f32_16x16x32_bf16 v[156:159], v[176:179], v[44:47], v[156:159]
    v_max3_u32 v13, v52, v53, v54
    v_max3_u32 v14, v55, v56, v57
    v_max3_u32 v15, v58, v59, v60
    v_mfma_f32_16x16x32_bf16 v[160:163], v[180:183], v[44:47], v[160:163]
    v_max3_u32 v13, v13, v61, v62
    v_max3_u32 v14, v14, v63, v64
    v_max3_u32 v15, v15, v65, v66
    v_mfma_f32_16x16x32_bf16 v[164:167], v[184:187], v[44:47], v[164:167]
    v_max3_u32 v13, v13, v14, v67
    v_max_u32 v13, v13, v15
    v_cmp_eq_u32 vcc, -1, v13
    v_mfma_f32_16x16x32_bf16 v[168:171], v[188:191], v[44:47], v[168:171]
    v_mfma_f32_16x16x32_bf16 v[172:175], v[192:195], v[44:47], v[172:175]
    s_bitset0_b32 s56, 0
    s_and_b64 vcc, vcc, s[14:15]
    s_cselect_b32 s48, 0x10, 0
    s_andn2_b32 s16, s16, s48
L_oa1:
    s_bitcmp0_b32 s16, 4
    s_cbranch_scc1 L_ob1
    v_mfma_f32_16x16x32_bf16 v[116:119], v[196:199], v[52:55], v[116:119]
    v_mfma_f32_16x16x32_bf16 v[120:123], v[200:203], v[52:55], v[120:123]
    v_mfma_f32_16x16x32_bf16 v[124:127], v[204:207], v[52:55], v[124:127]
    v_mfma_f32_16x16x32_bf16 v[128:131], v[208:211], v[52:55], v[128:131]
    v_mfma_f32_16x16x32_bf16 v[132:135], v[212:215], v[52:55], v[132:135]
    v_mfma_f32_16x16x32_bf16 v[136:139], v[196:199], v[56:59], v[136:139]
    v_mfma_f32_16x16x32_bf16 v[140:143], v[200:203], v[56:59], v[140:143]
    v_mfma_f32_16x16x32_bf16 v[144:147], v[204:207], v[56:59], v[144:147]
    v_mfma_f32_16x16x32_bf16 v[148:151], v[208:211], v[56:59], v[148:151]
    v_mfma_f32_16x16x32_bf16 v[152:155], v[212:215], v[56:59], v[152:155]
    s_lshr_b32 s48, s57, 9
    s_bcnt1_i32_b32 s48, s48
    s_waitcnt vmcnt(9)
    s_cmp_ge_u32 s48, 2
    s_cbranch_scc1 L_owa1
    s_waitcnt vmcnt(5)
    s_cmp_ge_u32 s48, 1
    s_cbranch_scc1 L_owa1
    s_waitcnt vmcnt(1)
L_owa1:
    v_mfma_f32_16x16x32_bf16 v[156:159], v[196:199], v[60:63], v[156:159]
    v_max3_u32 v13, v68, v69, v70
    v_max3_u32 v14, v71, v72, v73
    v_max3_u32 v15, v74, v75, v76
    v_mfma_f32_16x16x32_bf16 v[160:163], v[200:203], v[60:63], v[160:163]
    v_max3_u32 v13, v13, v77, v78
    v_max3_u32 v14, v14, v79, v80
    v_max3_u32 v15, v15, v81, v82
    v_mfma_f32_16x16x32_bf16 v[164:167], v[204:207], v[60:63], v[164:167]
    v_max3_u32 v13, v13, v14, v83
    v_max_u32 v13, v13, v15
    v_cmp_eq_u32 vcc, -1, v13
    v_mfma_f32_16x16x32_bf16 v[168:171], v[208:211], v[60:63], v[168:171]
    v_mfma_f32_16x16x32_bf16 v[172:175], v[212:215], v[60:63], v[172:175]
    s_bitset0_b32 s56, 4
    s_and_b64 vcc, vcc, s[14:15]
    s_cselect_b32 s48, 0x100, 0
    s_andn2_b32 s16, s16, s48
L_oa2:
    s_bitcmp0_b32 s16, 8
    s_cbranch_scc1 L_ob2
    v_mfma_f32_16x16x32_bf16 v[116:119], v[216:219], v[68:71], v[116:119]
    v_mfma_f32_16x16x32_bf16 v[120:123], v[220:223], v[68:71], v[120:123]
    v_mfma_f32_16x16x32_bf16 v[124:127], v[224:227], v[68:71], v[124:127]
    v_mfma_f32_16x16x32_bf16 v[128:131], v[228:231], v[68:71], v[128:131]
    v_mfma_f32_16x16x32_bf16 v[132:135], v[232:235], v[68:71], v[132:135]
    v_mfma_f32_16x16x32_bf16 v[136:139], v[216:219], v[72:75], v[136:139]
    v_mfma_f32_16x16x32_bf16 v[140:143], v[220:223], v[72:75], v[140:143]
    v_mfma_f32_16x16x32_bf16 v[144:147], v[224:227], v[72:75], v[144:147]
    v_mfma_f32_16x16x32_bf16 v[148:151], v[228:231], v[72:75], v[148:151]
    v_mfma_f32_16x16x32_bf16 v[152:155], v[232:235], v[72:75], v[152:155]
    s_lshr_b32 s48, s57, 13
    s_bcnt1_i32_b32 s48, s48
    s_waitcnt vmcnt(5)
    s_cmp_ge_u32 s48, 1
    s_cbranch_scc1 L_owa2
    s_waitcnt vmcnt(1)
L_owa2:
    v_mfma_f32_16x16x32_bf16 v[156:159], v[216:219], v[76:79], v[156:159]
    v_max3_u32 v13, v84, v85, v86
    v_max3_u32 v14, v87, v88, v89
    v_max3_u32 v15, v90, v91, v92
    v_mfma_f32_16x16x32_bf16 v[160:163], v[220:223], v[76:79], v[160:163]
    v_max3_u32 v13, v13, v93, v94
    v_max3_u32 v14, v14, v95, v96
    v_max3_u32 v15, v15, v97, v98
    v_mfma_f32_16x16x32_bf16 v[164:167], v[224:227], v[76:79], v[164:167]
    v_max3_u32 v13, v13, v14, v99
    v_max_u32 v13, v13, v15
    v_cmp_eq_u32 vcc, -1, v13
    v_mfma_f32_16x16x32_bf16 v[168:171], v[228:231], v[76:79], v[168:171]
    v_mfma_f32_16x16x32_bf16 v[172:175], v[232:235], v[76:79], v[172:175]
    s_bitset0_b32 s56, 8
    s_and_b64 vcc, vcc, s[14:15]
    s_cselect_b32 s48, 0x1000, 0
    s_andn2_b32 s16, s16, s48
L_oa3:
    s_bitcmp0_b32 s16, 12
    s_cbranch_scc1 L_ob3
    v_mfma_f32_16x16x32_bf16 v[116:119], v[236:239], v[84:87], v[116:119]
    v_mfma_f32_16x16x32_bf16 v[120:123], v[240:243], v[84:87], v[120:123]
    v_mfma_f32_16x16x32_bf16 v[124:127], v[244:247], v[84:87], v[124:127]
    v_mfma_f32_16x16x32_bf16 v[128:131], v[248:251], v[84:87], v[128:131]
    v_mfma_f32_16x16x32_bf16 v[132:135], v[252:255], v[84:87], v[132:135]
    v_mfma_f32_16x16x32_bf16 v[136:139], v[236:239], v[88:91], v[136:139]
    v_mfma_f32_16x16x32_bf16 v[140:143], v[240:243], v[88:91], v[140:143]
    v_mfma_f32_16x16x32_bf16 v[144:147], v[244:247], v[88:91], v[144:147]
    v_mfma_f32_16x16x32_bf16 v[148:151], v[248:251], v[88:91], v[148:151]
    v_mfma_f32_16x16x32_bf16 v[152:155], v[252:255], v[88:91], v[152:155]
    s_waitcnt vmcnt(1)
L_owa3:
    v_mfma_f32_16x16x32_bf16 v[156:159], v[236:239], v[92:95], v[156:159]
    v_max3_u32 v13, v100, v101, v102
    v_max3_u32 v14, v103, v104, v105
    v_max3_u32 v15, v106, v107, v108
    v_mfma_f32_16x16x32_bf16 v[160:163], v[240:243], v[92:95], v[160:163]
    v_max3_u32 v13, v13, v109, v110
    v_max3_u32 v14, v14, v111, v112
    v_max3_u32 v15, v15, v113, v114
    v_mfma_f32_16x16x32_bf16 v[164:167], v[244:247], v[92:95], v[164:167]
    v_max3_u32 v13, v13, v14, v115
    v_max_u32 v13, v13, v15
    v_cmp_eq_u32 vcc, -1, v13
    v_mfma_f32_16x16x32_bf16 v[168:171], v[248:251], v[92:95], v[168:171]
    v_mfma_f32_16x16x32_bf16 v[172:175], v[252:255], v[92:95], v[172:175]
    s_bitset0_b32 s56, 12
    s_and_b64 vcc, vcc, s[14:15]
    s_cselect_b32 s48, 0x10000, 0
    s_andn2_b32 s16, s16, s48
L_oa4:
    s_bitcmp0_b32 s16, 16
    s_cbranch_scc1 L_ob4
    v_mfma_f32_16x16x32_bf16 v[116:119], v[16:19], v[100:103], v[116:119]
    v_mfma_f32_16x16x32_bf16 v[120:123], v[20:23], v[100:103], v[120:123]
    v_mfma_f32_16x16x32_bf16 v[124:127], v[24:27], v[100:103], v[124:127]
    v_mfma_f32_16x16x32_bf16 v[128:131], v[28:31], v[100:103], v[128:131]
    v_mfma_f32_16x16x32_bf16 v[132:135], v[32:35], v[100:103], v[132:135]
    v_mfma_f32_16x16x32_bf16 v[136:139], v[16:19], v[104:107], v[136:139]
    v_mfma_f32_16x16x32_bf16 v[140:143], v[20:23], v[104:107], v[140:143]
    v_mfma_f32_16x16x32_bf16 v[144:147], v[24:27], v[104:107], v[144:147]
    v_mfma_f32_16x16x32_bf16 v[148:151], v[28:31], v[104:107], v[148:151]
    v_mfma_f32_16x16x32_bf16 v[152:155], v[32:35], v[104:107], v[152:155]
    v_mfma_f32_16x16x32_bf16 v[156:159], v[16:19], v[108:111], v[156:159]
    v_mfma_f32_16x16x32_bf16 v[160:163], v[20:23], v[108:111], v[160:163]
    v_mfma_f32_16x16x32_bf16 v[164:167], v[24:27], v[108:111], v[164:167]
    v_mfma_f32_16x16x32_bf16 v[168:171], v[28:31], v[108:111], v[168:171]
    v_mfma_f32_16x16x32_bf16 v[172:175], v[32:35], v[108:111], v[172:175]
    s_bitset0_b32 s56, 16
L_ob4:
    s_cmp_lg_u32 s56, 0
    s_cbranch_scc1 L_onext
    v_mov_b32 v6, s59
    ds_read_b32 v7, v6
    v_add_u32 v8, s11, v1
    v_mfma_f32_16x16x32_bf16 v[36:39], v[176:179], v[48:51], 0
    v_mfma_f32_16x16x32_bf16 v[52:55], v[180:183], v[48:51], 0
    v_mfma_f32_16x16x32_bf16 v[68:71], v[184:187], v[48:51], 0
    v_mfma_f32_16x16x32_bf16 v[84:87], v[188:191], v[48:51], 0
    v_mfma_f32_16x16x32_bf16 v[100:103], v[192:195], v[48:51], 0
    s_waitcnt lgkmcnt(0)
    v_readfirstlane_b32 s48, v7
    s_cmp_ge_u32 s48, 8
    s_cbranch_scc1 L_w3_done
    v_mov_b32 v6, s59
    s_mov_b32 s72, 0x40000
L_w3:
    ds_read_b32 v7, v6
    s_sub_u32 s72, s72, 1
    s_waitcnt lgkmcnt(0)
    v_readfirstlane_b32 s48, v7
    s_cbranch_scc1 L_w3_done
    s_cmp_ge_u32 s48, 8
    s_cbranch_scc1 L_w3_done
    s_sleep 1
    s_branch L_w3
L_w3_done:
    s_add_u32 s59, s59, 28
    ds_write_b128 v8, v[116:119] offset:0
    ds_write_b128 v8, v[120:123] offset:1024
    ds_write_b128 v8, v[124:127] offset:2048
    v_mfma_f32_16x16x32_bf16 v[36:39], v[196:199], v[64:67], v[36:39]
    ds_write_b128 v8, v[128:131] offset:3072
    ds_write_b128 v8, v[132:135] offset:4096
    ds_write_b128 v8, v[136:139] offset:5120
    v_mfma_f32_16x16x32_bf16 v[52:55], v[200:203], v[64:67], v[52:55]
    ds_write_b128 v8, v[140:143] offset:6144
    ds_write_b128 v8, v[144:147] offset:7168
    ds_write_b128 v8, v[148:151] offset:8192
    v_mfma_f32_16x16x32_bf16 v[68:71], v[204:207], v[64:67], v[68:71]
    ds_write_b128 v8, v[152:155] offset:9216
    ds_write_b128 v8, v[156:159] offset:10240
    ds_write_b128 v8, v[160:163] offset:11264
    v_mfma_f32_16x16x32_bf16 v[84:87], v[208:211], v[64:67], v[84:87]
    ds_write_b128 v8, v[164:167] offset:12288
    ds_write_b128 v8, v[168:171] offset:13312
    ds_write_b128 v8, v[172:175] offset:14336
    v_mfma_f32_16x16x32_bf16 v[100:103], v[212:215], v[64:67], v[100:103]
    v_mov_b32 v6, s59
    v_mov_b32 v7, 1
    s_mov_b64 exec, 1
    ds_add_u32 v6, v7
    s_mov_b64 exec, -1
    v_mfma_f32_16x16x32_bf16 v[36:39], v[216:219], v[80:83], v[36:39]
    v_mfma_f32_16x16x32_bf16 v[52:55], v[220:223], v[80:83], v[52:55]
    v_mfma_f32_16x16x32_bf16 v[68:71], v[224:227], v[80:83], v[68:71]
    v_mfma_f32_16x16x32_bf16 v[84:87], v[228:231], v[80:83], v[84:87]
    v_mfma_f32_16x16x32_bf16 v[100:103], v[232:235], v[80:83], v[100:103]
    v_lshrrev_b32 v13, 4, v0
    v_and_b32 v12, 15, v0
    v_mul_u32_u24 v12, 2560, v12
    v_lshl_add_u32 v12, v13, 3, v12
    v_mfma_f32_16x16x32_bf16 v[36:39], v[236:239], v[96:99], v[36:39]
    v_mfma_f32_16x16x32_bf16 v[52:55], v[240:243], v[96:99], v[52:55]
    v_mfma_f32_16x16x32_bf16 v[68:71], v[244:247], v[96:99], v[68:71]
    v_mfma_f32_16x16x32_bf16 v[84:87], v[248:251], v[96:99], v[84:87]
    v_mfma_f32_16x16x32_bf16 v[100:103], v[252:255], v[96:99], v[100:103]
    s_and_b32 s49, s40, 4
    s_sub_u32 s48, s40, 1
    s_and_b32 s48, s48, 3
    s_add_u32 s48, s48, s49
    s_mul_i32 s48, s48, 15360
    s_add_u32 s48, s48, 1024
    v_add_u32 v9, s48, v1
    s_sub_u32 s48, s40, 2
    s_and_b32 s48, s48, 3
    s_add_u32 s48, s48, s49
    s_mul_i32 s48, s48, 15360
    s_add_u32 s48, s48, 6144
    v_add_u32 v10, s48, v1
    s_sub_u32 s48, s40, 3
    s_and_b32 s48, s48, 3
    s_add_u32 s48, s48, s49
    s_mul_i32 s48, s48, 15360
    s_add_u32 s48, s48, 11264
    v_add_u32 v11, s48, v1
    v_mfma_f32_16x16x32_bf16 v[36:39], v[16:19], v[112:115], v[36:39]
    v_mfma_f32_16x16x32_bf16 v[52:55], v[20:23], v[112:115], v[52:55]
    v_mfma_f32_16x16x32_bf16 v[68:71], v[24:27], v[112:115], v[68:71]
    v_mfma_f32_16x16x32_bf16 v[84:87], v[28:31], v[112:115], v[84:87]
    v_mfma_f32_16x16x32_bf16 v[100:103], v[32:35], v[112:115], v[100:103]
    v_mov_b32 v6, s59
    s_mov_b32 s72, 0x40000
L_w10:
    ds_read_b32 v7, v6
    s_sub_u32 s72, s72, 1
    s_waitcnt lgkmcnt(0)
    v_readfirstlane_b32 s48, v7
    s_cbranch_scc1 L_w10_done
    s_cmp_ge_u32 s48, 4
    s_cbranch_scc1 L_w10_done
    s_sleep 1
    s_branch L_w10
L_w10_done:
    ds_read_b128 v[116:119], v9 offset:0
    ds_read_b128 v[136:139], v10 offset:0
    ds_read_b128 v[156:159], v11 offset:0
    ds_read_b128 v[120:123], v9 offset:1024
    ds_read_b128 v[140:143], v10 offset:1024
    ds_read_b128 v[160:163], v11 offset:1024
    ds_read_b128 v[124:127], v9 offset:2048
    ds_read_b128 v[144:147], v10 offset:2048
    ds_read_b128 v[164:167], v11 offset:2048
    ds_read_b128 v[128:131], v9 offset:3072
    ds_read_b128 v[148:151], v10 offset:3072
    ds_read_b128 v[168:171], v11 offset:3072
    ds_read_b128 v[132:135], v9 offset:4096
    ds_read_b128 v[152:155], v10 offset:4096
    ds_read_b128 v[172:175], v11 offset:4096
    s_waitcnt lgkmcnt(12)
    v_pk_add_f32 v[116:117], v[116:117], v[136:137]
    v_pk_add_f32 v[118:119], v[118:119], v[138:139]
    v_pk_add_f32 v[36:37], v[36:37], v[156:157]
    v_pk_add_f32 v[38:39], v[38:39], v[158:159]
    v_pk_add_f32 v[36:37], v[36:37], v[116:117]
    v_pk_add_f32 v[38:39], v[38:39], v[118:119]
    v_cvt_pk_bf16_f32 v36, v36, v37
    v_cvt_pk_bf16_f32 v37, v38, v39
    buffer_store_dwordx2 v[36:37], v12, s[36:39], s8 offen offset:0
    s_waitcnt lgkmcnt(9)
    v_pk_add_f32 v[120:121], v[120:121], v[140:141]
    v_pk_add_f32 v[122:123], v[122:123], v[142:143]
    v_pk_add_f32 v[52:53], v[52:53], v[160:161]
    v_pk_add_f32 v[54:55], v[54:55], v[162:163]
    v_pk_add_f32 v[52:53], v[52:53], v[120:121]
    v_pk_add_f32 v[54:55], v[54:55], v[122:123]
    v_cvt_pk_bf16_f32 v52, v52, v53
    v_cvt_pk_bf16_f32 v53, v54, v55
    buffer_store_dwordx2 v[52:53], v12, s[36:39], s8 offen offset:32
    s_waitcnt lgkmcnt(6)
    v_pk_add_f32 v[124:125], v[124:125], v[144:145]
    v_pk_add_f32 v[126:127], v[126:127], v[146:147]
    v_pk_add_f32 v[68:69], v[68:69], v[164:165]
    v_pk_add_f32 v[70:71], v[70:71], v[166:167]
    v_pk_add_f32 v[68:69], v[68:69], v[124:125]
    v_pk_add_f32 v[70:71], v[70:71], v[126:127]
    v_cvt_pk_bf16_f32 v68, v68, v69
    v_cvt_pk_bf16_f32 v69, v70, v71
    buffer_store_dwordx2 v[68:69], v12, s[36:39], s8 offen offset:64
    s_waitcnt lgkmcnt(3)
    v_pk_add_f32 v[128:129], v[128:129], v[148:149]
    v_pk_add_f32 v[130:131], v[130:131], v[150:151]
    v_pk_add_f32 v[84:85], v[84:85], v[168:169]
    v_pk_add_f32 v[86:87], v[86:87], v[170:171]
    v_pk_add_f32 v[84:85], v[84:85], v[128:129]
    v_pk_add_f32 v[86:87], v[86:87], v[130:131]
    v_cvt_pk_bf16_f32 v84, v84, v85
    v_cvt_pk_bf16_f32 v85, v86, v87
    buffer_store_dwordx2 v[84:85], v12, s[36:39], s8 offen offset:96
    s_waitcnt lgkmcnt(0)
    v_pk_add_f32 v[132:133], v[132:133], v[152:153]
    v_pk_add_f32 v[134:135], v[134:135], v[154:155]
    v_pk_add_f32 v[100:101], v[100:101], v[172:173]
    v_pk_add_f32 v[102:103], v[102:103], v[174:175]
    v_pk_add_f32 v[100:101], v[100:101], v[132:133]
    v_pk_add_f32 v[102:103], v[102:103], v[134:135]
    v_cvt_pk_bf16_f32 v100, v100, v101
    v_cvt_pk_bf16_f32 v101, v102, v103
    buffer_store_dwordx2 v[100:101], v12, s[36:39], s8 offen offset:128
L_end:
L_exit:
    s_endpgm
L_gh:
    s_cmp_eq_u32 s12, 19
    s_cbranch_scc1 L_gh19
    s_waitcnt lgkmcnt(0)
    s_cmp_lg_u64 s[78:79], 0
    s_cbranch_scc1 L_gn0_done
    v_mov_b32 v170, 0
    s_mov_b32 s72, 0x4000
L_gn0:
    global_load_dwordx2 v[172:173], v170, s[18:19] sc1
    s_sub_u32 s72, s72, 1
    s_waitcnt vmcnt(0)
    v_readfirstlane_b32 s78, v172
    v_readfirstlane_b32 s79, v173
    s_cmp_eq_u32 s72, 0
    s_cbranch_scc1 L_gn0_done
    s_sleep 8
    s_cmp_eq_u64 s[78:79], 0
    s_cbranch_scc1 L_gn0
L_gn0_done:
    v_mul_u32_u24 v170, 33024, v0
    v_mov_b64 v[172:173], s[78:79]
    s_lshr_b32 s48, s44, 1
    s_lshl3_add_u32 s48, s43, s48
    s_and_b32 s49, s44, 1
    s_lshl4_add_u32 s49, s48, s49
    s_lshl3_add_u32 s49, s49, 26214400
    s_mov_b32 exec_hi, 0
    buffer_store_dwordx2 v[172:173], v170, s[32:35], s49 offen sc1
    s_mov_b32 exec_hi, -1
    s_branch L_ghr
L_gh19:
    s_and_b32 s50, s56, 1
    s_lshl_b32 s48, s50, 10
    s_add_u32 s48, s48, s60
    s_lshl_b32 s49, s50, 3
    s_add_u32 s49, s49, s60
    buffer_load_dwordx4 v[24:27], v1, s[32:35], s48 offen sc1
    buffer_load_dwordx2 v[20:21], v23, s[32:35], s49 offen offset:2048 sc1
L_ghr:
    s_cmp_ge_u32 s43, 10
    s_cbranch_scc1 L_ghr_v
    s_branch L_ghr_qk
L_hm:
    v_mov_b64 v[16:17], s[78:79]
    v_lshlrev_b32 v18, 10, v0
    s_mov_b64 exec, 1
    buffer_store_dwordx2 v[16:17], v18, s[32:35], s22 offen sc1
    s_mov_b64 exec, -1
    s_branch L_hmr
L_dz:
    s_cmp_lg_u32 s54, 2
    s_cbranch_scc1 L_dz1
    buffer_store_dwordx4 v[208:211], v244, s[32:35], s26 offen sc1
    buffer_store_dwordx4 v[212:215], v246, s[32:35], s26 offen sc1
    buffer_store_dwordx4 v[224:227], v245, s[32:35], s26 offen sc1
    buffer_store_dwordx4 v[228:231], v247, s[32:35], s26 offen sc1
    s_branch L_hook0
L_dz1:
    v_mov_b32 v16, 36
    v_mov_b32 v17, 1
    s_waitcnt vmcnt(0)
    s_mov_b64 exec, 1
    ds_add_rtn_u32 v17, v16, v17
    s_mov_b64 exec, -1
    s_waitcnt lgkmcnt(0)
    v_readfirstlane_b32 s49, v17
    s_cmp_lg_u32 s49, 3
    s_cbranch_scc1 L_ahookr
    v_mul_u32_u24 v16, 33024, v0
    v_mov_b64 v[18:19], s[78:79]
    s_lshr_b32 s48, s44, 1
    s_lshl3_add_u32 s48, s43, s48
    s_and_b32 s49, s44, 1
    s_lshl4_add_u32 s49, s48, s49
    s_lshl3_add_u32 s49, s49, 26230784
    s_mov_b32 exec_hi, 0
    buffer_store_dwordx2 v[18:19], v16, s[32:35], s49 offen sc1
    s_mov_b32 exec_hi, -1
    s_branch L_ahookr
L_hook:
    s_bitcmp1_b32 s28, s54
    s_cbranch_scc1 L_dz
L_hook0:
    s_lshl_b32 s48, s54, 2
    v_mov_b32 v16, s48
    v_mov_b32 v17, 1
    s_mov_b64 exec, 1
    ds_add_u32 v16, v17
    s_mov_b64 exec, -1
    s_sub_u32 s48, s54, s58
    s_cmp_eq_u32 s48, 1
    s_waitcnt lgkmcnt(0)
    s_cbranch_scc1 L_h7
    s_cmp_lg_u32 s48, 0
    s_cbranch_scc1 L_ahookr
    v_bfe_u32 v16, v0, 3, 1
    v_mul_u32_u24 v16, 19, v16
    s_mul_i32 s48, s45, 20
    v_add_u32 v16, s48, v16
    v_lshrrev_b32 v16, 7, v16
    v_lshrrev_b32 v17, 4, v0
    v_min_u32 v17, 2, v17
    v_mad_u32_u24 v16, v17, 5, v16
    s_mul_i32 s48, s42, 33024
    v_and_b32 v170, 1, v0
    v_sub_u32 v170, s46, v170
    v_max_i32 v170, 0, v170
    v_add_u32 v170, 0x80, v170
    v_lshl_add_u32 v170, v16, 3, v170
    v_lshl_add_u32 v170, v170, 7, s48
    s_lshr_b32 s49, s45, 4
    s_lshl_b32 s49, s49, 3
    s_add_u32 s49, s49, s46
    s_add_u32 s50, s46, 248
    s_lshl_b32 s50, s50, 7
    s_add_u32 s50, s50, s48
    v_writelane_b32 v170, s50, 63
    s_lshl_b32 s49, s49, 2
    s_and_b32 s50, s40, 3
    s_add_u32 s49, s49, s50
    s_mul_i32 s77, s49, 25600
    s_add_u32 s77, s77, 23068672
    buffer_load_dwordx4 v[172:175], v170, s[32:35], s47 offen sc1
    s_branch L_ahookr
L_h7:
    s_waitcnt vmcnt(0)
    s_mov_b32 s72, 0x4000
L_bpoll:
    v_cmp_ne_u64 vcc, s[78:79], v[172:173]
    v_cmp_ne_u64 s[48:49], s[78:79], v[174:175]
    s_nop 0
    s_or_b64 vcc, vcc, s[48:49]
    s_cbranch_scc0 L_bpoll_done
    s_sub_u32 s72, s72, 1
    s_cbranch_scc1 L_bpoll_done
    s_sleep 2
    s_mov_b64 exec, vcc
    buffer_load_dwordx4 v[172:175], v170, s[32:35], s47 offen sc1
    s_mov_b64 exec, -1
    s_waitcnt vmcnt(0)
    s_branch L_bpoll
L_bpoll_done:
    s_cmp_ge_u32 s40, 4
    s_cbranch_scc1 L_h7w
    v_mov_b32 v16, 8
    s_mov_b32 s72, 0x40000
L_w2:
    ds_read_b32 v17, v16
    s_sub_u32 s72, s72, 1
    s_waitcnt lgkmcnt(0)
    v_readfirstlane_b32 s48, v17
    s_cbranch_scc1 L_w2_done
    s_cmp_ge_u32 s48, 8
    s_cbranch_scc1 L_w2_done
    s_sleep 1
    s_branch L_w2
L_w2_done:
    s_and_b32 s50, s56, 1
    s_lshl_b32 s48, s50, 10
    s_add_u32 s48, s48, s60
    s_lshl_b32 s49, s50, 3
    s_add_u32 s49, s49, s60
    s_add_u32 s48, s48, 8388608
    s_add_u32 s49, s49, 8388608
    buffer_load_dwordx4 v[32:35], v1, s[32:35], s48 offen sc1
    buffer_load_dwordx2 v[40:41], v23, s[32:35], s49 offen offset:2048 sc1
    s_add_u32 s48, s48, 5120
    s_add_u32 s49, s49, 5120
    buffer_load_dwordx4 v[170:173], v1, s[32:35], s48 offen sc1
    buffer_load_dwordx2 v[174:175], v23, s[32:35], s49 offen offset:2048 sc1
    s_lshl_b32 s53, s40, 10
    s_mul_i32 s50, s46, 20480
    s_add_u32 s50, s50, s53
    s_add_u32 s51, s63, 8388608
    s_add_u32 m0, s53, 1024
    s_add_i32 s52, s50, 0xffffb000
    s_max_i32 s52, s52, 0
    s_add_u32 s52, s52, s51
    buffer_load_dwordx4 v1, s[32:35], s52 offen sc1 lds
    s_add_u32 m0, s53, 5120
    s_add_i32 s52, s50, 0xffffc000
    s_max_i32 s52, s52, 0
    s_add_u32 s52, s52, s51
    buffer_load_dwordx4 v1, s[32:35], s52 offen sc1 lds
    s_add_u32 m0, s53, 9216
    s_add_i32 s52, s50, 0xffffd000
    s_max_i32 s52, s52, 0
    s_add_u32 s52, s52, s51
    buffer_load_dwordx4 v1, s[32:35], s52 offen sc1 lds
    s_add_u32 m0, s53, 13312
    s_add_i32 s52, s50, 0xffffe000
    s_max_i32 s52, s52, 0
    s_add_u32 s52, s52, s51
    buffer_load_dwordx4 v1, s[32:35], s52 offen sc1 lds
    s_add_u32 m0, s53, 17408
    s_add_i32 s52, s50, 0xfffff000
    s_max_i32 s52, s52, 0
    s_add_u32 s52, s52, s51
    buffer_load_dwordx4 v1, s[32:35], s52 offen sc1 lds
    s_add_u32 m0, s53, 21504
    s_add_i32 s52, s50, 0x0
    s_max_i32 s52, s52, 0
    s_add_u32 s52, s52, s51
    buffer_load_dwordx4 v1, s[32:35], s52 offen sc1 lds
    s_add_u32 m0, s53, 25600
    s_add_i32 s52, s50, 0x1000
    s_max_i32 s52, s52, 0
    s_add_u32 s52, s52, s51
    buffer_load_dwordx4 v1, s[32:35], s52 offen sc1 lds
    s_add_u32 m0, s53, 29696
    s_add_i32 s52, s50, 0x2000
    s_max_i32 s52, s52, 0
    s_add_u32 s52, s52, s51
    buffer_load_dwordx4 v1, s[32:35], s52 offen sc1 lds
    s_add_u32 m0, s53, 33792
    s_add_i32 s52, s50, 0x3000
    s_max_i32 s52, s52, 0
    s_add_u32 s52, s52, s51
    buffer_load_dwordx4 v1, s[32:35], s52 offen sc1 lds
    s_add_u32 m0, s53, 37888
    s_add_i32 s52, s50, 0x4000
    s_max_i32 s52, s52, 0
    s_add_u32 s52, s52, s51
    buffer_load_dwordx4 v1, s[32:35], s52 offen sc1 lds
L_h7w:
    s_lshr_b32 s51, s45, 4
    s_bfe_u32 s52, s45, 0x30001
    s_lshl_b32 s52, s52, 2
    s_and_b32 s48, s45, 1
    s_add_u32 s52, s52, s48
    s_lshl_b32 s52, s52, 2
    s_and_b32 s48, s40, 4
    s_add_u32 s52, s52, s48
    s_add_u32 s52, s52, s40
    s_and_b32 s53, s40, 3
    s_lshl_b32 s9, s52, 7
    s_lshl_b32 s48, s51, 16
    s_add_u32 s9, s9, s48
    s_add_u32 s9, s9, 25231360
    s_mul_i32 s49, s51, 2621440
    s_andn2_b32 s50, s52, 3
    s_mul_i32 s50, s50, 20480
    s_add_u32 s49, s49, s50
    s_lshl_b32 s50, s53, 12
    s_add_u32 s49, s49, s50
    s_add_u32 s49, s49, 16777216
    s_add_u32 s48, s40, 1
    s_and_b32 s48, s48, 3
    s_mul_i32 s48, s48, 20480
    s_add_u32 s4, s49, s48
    s_add_u32 s48, s40, 2
    s_and_b32 s48, s48, 3
    s_mul_i32 s48, s48, 20480
    s_add_u32 s5, s49, s48
    s_add_u32 s48, s40, 3
    s_and_b32 s48, s48, 3
    s_mul_i32 s48, s48, 20480
    s_add_u32 s6, s49, s48
    s_add_u32 s48, s40, 4
    s_and_b32 s48, s48, 3
    s_mul_i32 s48, s48, 20480
    s_add_u32 s7, s49, s48
    s_mul_i32 s48, s53, 3072
    s_sub_u32 s10, 16384, s48
    s_mul_i32 s8, s52, 40960
    s_mul_i32 s48, s51, 1280
    s_add_u32 s8, s8, s48
    s_mul_i32 s50, s46, 160
    s_add_u32 s8, s8, s50
    s_mul_i32 s48, s40, 15360
    s_add_u32 s11, s48, 1024
    s_mov_b64 s[12:13], 0
    s_mov_b64 s[14:15], 0
    s_mov_b32 s17, 1
    buffer_load_dwordx4 v[176:179], v1, s[32:35], s77 offen offset:0 sc1
    buffer_load_dwordx4 v[180:183], v1, s[32:35], s77 offen offset:1024 sc1
    buffer_load_dwordx4 v[184:187], v1, s[32:35], s77 offen offset:2048 sc1
    buffer_load_dwordx4 v[188:191], v1, s[32:35], s77 offen offset:3072 sc1
    s_add_u32 s77, s77, 4096
    buffer_load_dwordx4 v[192:195], v1, s[32:35], s77 offen offset:0 sc1
    buffer_load_dwordx4 v[196:199], v1, s[32:35], s77 offen offset:1024 sc1
    buffer_load_dwordx4 v[200:203], v1, s[32:35], s77 offen offset:2048 sc1
    buffer_load_dwordx4 v[204:207], v1, s[32:35], s77 offen offset:3072 sc1
    s_add_u32 s77, s77, 4096
    buffer_load_dwordx4 v[208:211], v1, s[32:35], s77 offen offset:0 sc1
    buffer_load_dwordx4 v[212:215], v1, s[32:35], s77 offen offset:1024 sc1
    buffer_load_dwordx4 v[216:219], v1, s[32:35], s77 offen offset:2048 sc1
    buffer_load_dwordx4 v[220:223], v1, s[32:35], s77 offen offset:3072 sc1
    s_add_u32 s77, s77, 4096
    buffer_load_dwordx4 v[224:227], v1, s[32:35], s77 offen offset:0 sc1
    buffer_load_dwordx4 v[228:231], v1, s[32:35], s77 offen offset:1024 sc1
    buffer_load_dwordx4 v[232:235], v1, s[32:35], s77 offen offset:2048 sc1
    buffer_load_dwordx4 v[236:239], v1, s[32:35], s77 offen offset:3072 sc1
    s_add_u32 s77, s77, 4096
    buffer_load_dwordx4 v[240:243], v1, s[32:35], s77 offen offset:0 sc1
    buffer_load_dwordx4 v[244:247], v1, s[32:35], s77 offen offset:1024 sc1
    buffer_load_dwordx4 v[248:251], v1, s[32:35], s77 offen offset:2048 sc1
    buffer_load_dwordx4 v[252:255], v1, s[32:35], s77 offen offset:3072 sc1
    s_add_u32 s77, s77, 4096
    s_branch L_ahookr
L_lim2:
    s_nop 7
    s_nop 3
    v_mov_b64 v[100:101], s[70:71]
    v_mov_b64 v[102:103], s[70:71]
    v_mov_b64 v[104:105], s[70:71]
    v_mov_b64 v[106:107], s[70:71]
    v_mov_b64 v[108:109], s[70:71]
    v_mov_b64 v[110:111], s[70:71]
    v_mov_b64 v[112:113], s[70:71]
    v_mov_b64 v[114:115], s[70:71]
    s_nop 1
    s_branch L_limr2
L_lim3:
    s_nop 7
    s_nop 3
    v_mov_b64 v[100:101], s[70:71]
    v_mov_b64 v[102:103], s[70:71]
    v_mov_b64 v[104:105], s[70:71]
    v_mov_b64 v[106:107], s[70:71]
    v_mov_b64 v[108:109], s[70:71]
    v_mov_b64 v[110:111], s[70:71]
    v_mov_b64 v[112:113], s[70:71]
    v_mov_b64 v[114:115], s[70:71]
    s_nop 1
    s_branch L_limr3
L_lim4:
    s_nop 7
    s_nop 3
    v_mov_b64 v[100:101], s[70:71]
    v_mov_b64 v[102:103], s[70:71]
    v_mov_b64 v[104:105], s[70:71]
    v_mov_b64 v[106:107], s[70:71]
    v_mov_b64 v[108:109], s[70:71]
    v_mov_b64 v[110:111], s[70:71]
    v_mov_b64 v[112:113], s[70:71]
    v_mov_b64 v[114:115], s[70:71]
    s_nop 1
    s_branch L_limr4
L_lim5:
    s_nop 7
    s_nop 3
    v_mov_b64 v[100:101], s[70:71]
    v_mov_b64 v[102:103], s[70:71]
    v_mov_b64 v[104:105], s[70:71]
    v_mov_b64 v[106:107], s[70:71]
    v_mov_b64 v[108:109], s[70:71]
    v_mov_b64 v[110:111], s[70:71]
    v_mov_b64 v[112:113], s[70:71]
    v_mov_b64 v[114:115], s[70:71]
    s_nop 1
    s_branch L_limr5
L_lim6:
    s_nop 7
    s_nop 3
    v_mov_b64 v[100:101], s[70:71]
    v_mov_b64 v[102:103], s[70:71]
    v_mov_b64 v[104:105], s[70:71]
    v_mov_b64 v[106:107], s[70:71]
    v_mov_b64 v[108:109], s[70:71]
    v_mov_b64 v[110:111], s[70:71]
    v_mov_b64 v[112:113], s[70:71]
    v_mov_b64 v[114:115], s[70:71]
    s_nop 1
    s_branch L_limr6
L_lim7:
    s_nop 7
    s_nop 3
    v_mov_b64 v[100:101], s[70:71]
    v_mov_b64 v[102:103], s[70:71]
    v_mov_b64 v[104:105], s[70:71]
    v_mov_b64 v[106:107], s[70:71]
    v_mov_b64 v[108:109], s[70:71]
    v_mov_b64 v[110:111], s[70:71]
    v_mov_b64 v[112:113], s[70:71]
    v_mov_b64 v[114:115], s[70:71]
    s_nop 1
    s_branch L_limr7
L_lim8:
    s_nop 7
    s_nop 3
    v_mov_b64 v[100:101], s[70:71]
    v_mov_b64 v[102:103], s[70:71]
    v_mov_b64 v[104:105], s[70:71]
    v_mov_b64 v[106:107], s[70:71]
    v_mov_b64 v[108:109], s[70:71]
    v_mov_b64 v[110:111], s[70:71]
    v_mov_b64 v[112:113], s[70:71]
    v_mov_b64 v[114:115], s[70:71]
    s_nop 1
    s_branch L_limr8
L_ob0:
    s_bitcmp0_b32 s57, 4
    s_cbranch_scc1 L_ob1
    s_lshr_b32 s48, s57, 5
    s_bcnt1_i32_b32 s48, s48
    s_waitcnt vmcnt(13)
    s_cmp_ge_u32 s48, 3
    s_cbranch_scc1 L_owb0
    s_waitcnt vmcnt(9)
    s_cmp_ge_u32 s48, 2
    s_cbranch_scc1 L_owb0
    s_waitcnt vmcnt(5)
    s_cmp_ge_u32 s48, 1
    s_cbranch_scc1 L_owb0
    s_waitcnt vmcnt(1)
L_owb0:
    v_max3_u32 v13, v52, v53, v54
    v_max3_u32 v14, v55, v56, v57
    v_max3_u32 v15, v58, v59, v60
    v_max3_u32 v13, v13, v61, v62
    v_max3_u32 v14, v14, v63, v64
    v_max3_u32 v15, v15, v65, v66
    v_max3_u32 v13, v13, v14, v67
    v_max_u32 v13, v13, v15
    v_cmp_eq_u32 vcc, -1, v13
    s_nop 0
    s_and_b64 vcc, vcc, s[14:15]
    s_cselect_b32 s48, 0x10, 0
    s_andn2_b32 s16, s16, s48
    s_branch L_oa1
L_ob1:
    s_bitcmp0_b32 s57, 8
    s_cbranch_scc1 L_ob2
    s_lshr_b32 s48, s57, 9
    s_bcnt1_i32_b32 s48, s48
    s_waitcnt vmcnt(9)
    s_cmp_ge_u32 s48, 2
    s_cbranch_scc1 L_owb1
    s_waitcnt vmcnt(5)
    s_cmp_ge_u32 s48, 1
    s_cbranch_scc1 L_owb1
    s_waitcnt vmcnt(1)
L_owb1:
    v_max3_u32 v13, v68, v69, v70
    v_max3_u32 v14, v71, v72, v73
    v_max3_u32 v15, v74, v75, v76
    v_max3_u32 v13, v13, v77, v78
    v_max3_u32 v14, v14, v79, v80
    v_max3_u32 v15, v15, v81, v82
    v_max3_u32 v13, v13, v14, v83
    v_max_u32 v13, v13, v15
    v_cmp_eq_u32 vcc, -1, v13
    s_nop 0
    s_and_b64 vcc, vcc, s[14:15]
    s_cselect_b32 s48, 0x100, 0
    s_andn2_b32 s16, s16, s48
    s_branch L_oa2
L_ob2:
    s_bitcmp0_b32 s57, 12
    s_cbranch_scc1 L_ob3
    s_lshr_b32 s48, s57, 13
    s_bcnt1_i32_b32 s48, s48
    s_waitcnt vmcnt(5)
    s_cmp_ge_u32 s48, 1
    s_cbranch_scc1 L_owb2
    s_waitcnt vmcnt(1)
L_owb2:
    v_max3_u32 v13, v84, v85, v86
    v_max3_u32 v14, v87, v88, v89
    v_max3_u32 v15, v90, v91, v92
    v_max3_u32 v13, v13, v93, v94
    v_max3_u32 v14, v14, v95, v96
    v_max3_u32 v15, v15, v97, v98
    v_max3_u32 v13, v13, v14, v99
    v_max_u32 v13, v13, v15
    v_cmp_eq_u32 vcc, -1, v13
    s_nop 0
    s_and_b64 vcc, vcc, s[14:15]
    s_cselect_b32 s48, 0x1000, 0
    s_andn2_b32 s16, s16, s48
    s_branch L_oa3
L_ob3:
    s_bitcmp0_b32 s57, 16
    s_cbranch_scc1 L_ob4
    s_waitcnt vmcnt(1)
L_owb3:
    v_max3_u32 v13, v100, v101, v102
    v_max3_u32 v14, v103, v104, v105
    v_max3_u32 v15, v106, v107, v108
    v_max3_u32 v13, v13, v109, v110
    v_max3_u32 v14, v14, v111, v112
    v_max3_u32 v15, v15, v113, v114
    v_max3_u32 v13, v13, v14, v115
    v_max_u32 v13, v13, v15
    v_cmp_eq_u32 vcc, -1, v13
    s_nop 0
    s_and_b64 vcc, vcc, s[14:15]
    s_cselect_b32 s48, 0x10000, 0
    s_andn2_b32 s16, s16, s48
    s_branch L_oa4
L_wt:
    s_mov_b32 s43, 15
    s_sub_u32 s51, s42, 30
    s_lshl_b32 s44, s51, 3
    s_add_u32 s44, s44, s41
    s_waitcnt lgkmcnt(0)
    s_mov_b32 s32, s20
    s_and_b32 s33, s21, 0xffff
    s_mov_b32 s34, 268435456
    s_mov_b32 s35, 0x00020000
    s_mov_b32 s36, s16
    s_and_b32 s37, s17, 0xffff
    s_mov_b32 s38, 5242880
    s_mov_b32 s39, 0x00020000
    s_mov_b64 s[78:79], 0
    s_cmp_lt_u32 s40, 4
    s_cbranch_scc1 L_wt0
    v_bfe_u32 v172, v0, 3, 1
    v_mul_u32_u24 v172, 19, v172
    s_mul_i32 s48, s45, 20
    v_add_u32 v172, s48, v172
    v_lshrrev_b32 v172, 7, v172
    v_lshrrev_b32 v173, 4, v0
    v_min_u32 v173, 2, v173
    v_mad_u32_u24 v172, v173, 5, v172
    s_mul_i32 s48, s42, 33024
    v_and_b32 v170, 7, v0
    s_mov_b64 exec, 0xffff
    v_mov_b32 v170, s46
    s_mov_b64 exec, -1
    v_lshl_add_u32 v170, v172, 3, v170
    v_lshl_add_u32 v170, v170, 7, s48
    v_mov_b64 v[172:173], 0
    v_mov_b64 v[174:175], 0
    s_barrier
    s_branch L_ld_su
L_wt0:
    s_cmp_eq_u32 s51, 1
    s_cselect_b64 s[48:49], s[14:15], s[8:9]
    s_mov_b32 s24, s48
    s_and_b32 s25, s49, 0xffff
    s_mov_b32 s26, 819200
    s_mov_b32 s27, 0x00020000
    v_lshlrev_b32 v1, 4, v0
    v_add_u32 v8, 0, v0
    v_mul_u32_u24 v9, 205, v8
    v_lshrrev_b32 v9, 11, v9
    v_mul_u32_u24 v9, 1120, v9
    v_lshl_add_u32 v2, v8, 4, v9
    v_add_u32 v8, 64, v0
    v_mul_u32_u24 v9, 205, v8
    v_lshrrev_b32 v9, 11, v9
    v_mul_u32_u24 v9, 1120, v9
    v_lshl_add_u32 v3, v8, 4, v9
    v_add_u32 v8, 128, v0
    v_mul_u32_u24 v9, 205, v8
    v_lshrrev_b32 v9, 11, v9
    v_mul_u32_u24 v9, 1120, v9
    v_lshl_add_u32 v4, v8, 4, v9
    v_add_u32 v8, 192, v0
    v_mul_u32_u24 v9, 205, v8
    v_lshrrev_b32 v9, 11, v9
    v_mul_u32_u24 v9, 1120, v9
    v_lshl_add_u32 v5, v8, 4, v9
    v_add_u32 v8, 256, v0
    v_mul_u32_u24 v9, 205, v8
    v_lshrrev_b32 v9, 11, v9
    v_mul_u32_u24 v9, 1120, v9
    v_lshl_add_u32 v6, v8, 4, v9
    s_mul_i32 s53, s40, 25600
    s_mul_i32 s50, s41, 160
    s_mul_i32 s49, s40, 204800
    s_add_u32 s52, s49, s50
    s_add_u32 m0, s53, 0
    s_add_u32 s48, s52, 0
    buffer_load_dwordx4 v2, s[24:27], s48 offen lds
    s_add_u32 m0, s53, 1024
    s_add_u32 s48, s52, 0
    buffer_load_dwordx4 v3, s[24:27], s48 offen lds
    s_add_u32 m0, s53, 2048
    s_add_u32 s48, s52, 0
    buffer_load_dwordx4 v4, s[24:27], s48 offen lds
    s_add_u32 m0, s53, 3072
    s_add_u32 s48, s52, 0
    buffer_load_dwordx4 v5, s[24:27], s48 offen lds
    s_add_u32 m0, s53, 4096
    s_add_u32 s48, s52, 0
    buffer_load_dwordx4 v6, s[24:27], s48 offen lds
    s_add_u32 m0, s53, 5120
    s_add_u32 s48, s52, 40960
    buffer_load_dwordx4 v2, s[24:27], s48 offen lds
    s_add_u32 m0, s53, 6144
    s_add_u32 s48, s52, 40960
    buffer_load_dwordx4 v3, s[24:27], s48 offen lds
    s_add_u32 m0, s53, 7168
    s_add_u32 s48, s52, 40960
    buffer_load_dwordx4 v4, s[24:27], s48 offen lds
    s_add_u32 m0, s53, 8192
    s_add_u32 s48, s52, 40960
    buffer_load_dwordx4 v5, s[24:27], s48 offen lds
    s_add_u32 m0, s53, 9216
    s_add_u32 s48, s52, 40960
    buffer_load_dwordx4 v6, s[24:27], s48 offen lds
    s_add_u32 m0, s53, 10240
    s_add_u32 s48, s52, 81920
    buffer_load_dwordx4 v2, s[24:27], s48 offen lds
    s_add_u32 m0, s53, 11264
    s_add_u32 s48, s52, 81920
    buffer_load_dwordx4 v3, s[24:27], s48 offen lds
    s_add_u32 m0, s53, 12288
    s_add_u32 s48, s52, 81920
    buffer_load_dwordx4 v4, s[24:27], s48 offen lds
    s_add_u32 m0, s53, 13312
    s_add_u32 s48, s52, 81920
    buffer_load_dwordx4 v5, s[24:27], s48 offen lds
    s_add_u32 m0, s53, 14336
    s_add_u32 s48, s52, 81920
    buffer_load_dwordx4 v6, s[24:27], s48 offen lds
    s_add_u32 m0, s53, 15360
    s_add_u32 s48, s52, 122880
    buffer_load_dwordx4 v2, s[24:27], s48 offen lds
    s_add_u32 m0, s53, 16384
    s_add_u32 s48, s52, 122880
    buffer_load_dwordx4 v3, s[24:27], s48 offen lds
    s_add_u32 m0, s53, 17408
    s_add_u32 s48, s52, 122880
    buffer_load_dwordx4 v4, s[24:27], s48 offen lds
    s_add_u32 m0, s53, 18432
    s_add_u32 s48, s52, 122880
    buffer_load_dwordx4 v5, s[24:27], s48 offen lds
    s_add_u32 m0, s53, 19456
    s_add_u32 s48, s52, 122880
    buffer_load_dwordx4 v6, s[24:27], s48 offen lds
    s_add_u32 m0, s53, 20480
    s_add_u32 s48, s52, 163840
    buffer_load_dwordx4 v2, s[24:27], s48 offen lds
    s_add_u32 m0, s53, 21504
    s_add_u32 s48, s52, 163840
    buffer_load_dwordx4 v3, s[24:27], s48 offen lds
    s_add_u32 m0, s53, 22528
    s_add_u32 s48, s52, 163840
    buffer_load_dwordx4 v4, s[24:27], s48 offen lds
    s_add_u32 m0, s53, 23552
    s_add_u32 s48, s52, 163840
    buffer_load_dwordx4 v5, s[24:27], s48 offen lds
    s_add_u32 m0, s53, 24576
    s_add_u32 s48, s52, 163840
    buffer_load_dwordx4 v6, s[24:27], s48 offen lds
    v_bfe_u32 v8, v0, 2, 2
    v_and_b32 v9, 3, v0
    v_lshl_add_u32 v9, v9, 3, s53
    v_lshrrev_b32 v10, 4, v0
    v_mul_u32_u24 v11, 20, v10
    v_add3_u32 v11, v11, v8, 16
    v_mul_u32_u24 v11, 160, v11
    v_add_u32 v13, v11, v9
    v_lshrrev_b32 v11, 5, v0
    v_mul_u32_u24 v11, 20, v11
    v_bfe_u32 v12, v0, 4, 1
    v_lshl_add_u32 v11, v12, 2, v11
    v_add_u32 v11, v11, v8
    v_mul_u32_u24 v11, 160, v11
    v_add_u32 v7, v11, v9
    s_mul_i32 s48, s44, 102400
    s_add_u32 s48, s48, s53
    s_add_u32 s48, s48, 23068672
    s_waitcnt vmcnt(0)
    ds_read_b64_tr_b16 v[16:17], v7 offset:0
    ds_read_b64_tr_b16 v[18:19], v7 offset:1280
    ds_read_b64_tr_b16 v[20:21], v7 offset:32
    ds_read_b64_tr_b16 v[22:23], v7 offset:1312
    ds_read_b64_tr_b16 v[24:25], v7 offset:64
    ds_read_b64_tr_b16 v[26:27], v7 offset:1344
    ds_read_b64_tr_b16 v[28:29], v7 offset:96
    ds_read_b64_tr_b16 v[30:31], v7 offset:1376
    ds_read_b64_tr_b16 v[32:33], v7 offset:128
    ds_read_b64_tr_b16 v[34:35], v7 offset:1408
    ds_read_b64_tr_b16 v[36:37], v7 offset:6400
    ds_read_b64_tr_b16 v[38:39], v7 offset:7680
    ds_read_b64_tr_b16 v[40:41], v7 offset:6432
    ds_read_b64_tr_b16 v[42:43], v7 offset:7712
    ds_read_b64_tr_b16 v[44:45], v7 offset:6464
    ds_read_b64_tr_b16 v[46:47], v7 offset:7744
    ds_read_b64_tr_b16 v[48:49], v7 offset:6496
    ds_read_b64_tr_b16 v[50:51], v7 offset:7776
    ds_read_b64_tr_b16 v[52:53], v7 offset:6528
    ds_read_b64_tr_b16 v[54:55], v7 offset:7808
    ds_read_b64_tr_b16 v[56:57], v7 offset:12800
    ds_read_b64_tr_b16 v[58:59], v7 offset:14080
    ds_read_b64_tr_b16 v[60:61], v7 offset:12832
    ds_read_b64_tr_b16 v[62:63], v7 offset:14112
    ds_read_b64_tr_b16 v[64:65], v7 offset:12864
    ds_read_b64_tr_b16 v[66:67], v7 offset:14144
    ds_read_b64_tr_b16 v[68:69], v7 offset:12896
    ds_read_b64_tr_b16 v[70:71], v7 offset:14176
    ds_read_b64_tr_b16 v[72:73], v7 offset:12928
    ds_read_b64_tr_b16 v[74:75], v7 offset:14208
    ds_read_b64_tr_b16 v[76:77], v7 offset:19200
    ds_read_b64_tr_b16 v[78:79], v7 offset:20480
    ds_read_b64_tr_b16 v[80:81], v7 offset:19232
    ds_read_b64_tr_b16 v[82:83], v7 offset:20512
    ds_read_b64_tr_b16 v[84:85], v7 offset:19264
    ds_read_b64_tr_b16 v[86:87], v7 offset:20544
    ds_read_b64_tr_b16 v[88:89], v7 offset:19296
    ds_read_b64_tr_b16 v[90:91], v7 offset:20576
    ds_read_b64_tr_b16 v[92:93], v7 offset:19328
    ds_read_b64_tr_b16 v[94:95], v7 offset:20608
    ds_read_b64_tr_b16 v[96:97], v13 offset:0
    ds_read_b64_tr_b16 v[98:99], v13 offset:12800
    ds_read_b64_tr_b16 v[100:101], v13 offset:32
    ds_read_b64_tr_b16 v[102:103], v13 offset:12832
    ds_read_b64_tr_b16 v[104:105], v13 offset:64
    ds_read_b64_tr_b16 v[106:107], v13 offset:12864
    ds_read_b64_tr_b16 v[108:109], v13 offset:96
    ds_read_b64_tr_b16 v[110:111], v13 offset:12896
    ds_read_b64_tr_b16 v[112:113], v13 offset:128
    ds_read_b64_tr_b16 v[114:115], v13 offset:12928
    s_waitcnt lgkmcnt(0)
    buffer_store_dwordx4 v[16:19], v1, s[32:35], s48 offen offset:0 sc1
    buffer_store_dwordx4 v[20:23], v1, s[32:35], s48 offen offset:1024 sc1
    buffer_store_dwordx4 v[24:27], v1, s[32:35], s48 offen offset:2048 sc1
    buffer_store_dwordx4 v[28:31], v1, s[32:35], s48 offen offset:3072 sc1
    s_add_u32 s48, s48, 4096
    buffer_store_dwordx4 v[32:35], v1, s[32:35], s48 offen offset:0 sc1
    buffer_store_dwordx4 v[36:39], v1, s[32:35], s48 offen offset:1024 sc1
    buffer_store_dwordx4 v[40:43], v1, s[32:35], s48 offen offset:2048 sc1
    buffer_store_dwordx4 v[44:47], v1, s[32:35], s48 offen offset:3072 sc1
    s_add_u32 s48, s48, 4096
    buffer_store_dwordx4 v[48:51], v1, s[32:35], s48 offen offset:0 sc1
    buffer_store_dwordx4 v[52:55], v1, s[32:35], s48 offen offset:1024 sc1
    buffer_store_dwordx4 v[56:59], v1, s[32:35], s48 offen offset:2048 sc1
    buffer_store_dwordx4 v[60:63], v1, s[32:35], s48 offen offset:3072 sc1
    s_add_u32 s48, s48, 4096
    buffer_store_dwordx4 v[64:67], v1, s[32:35], s48 offen offset:0 sc1
    buffer_store_dwordx4 v[68:71], v1, s[32:35], s48 offen offset:1024 sc1
    buffer_store_dwordx4 v[72:75], v1, s[32:35], s48 offen offset:2048 sc1
    buffer_store_dwordx4 v[76:79], v1, s[32:35], s48 offen offset:3072 sc1
    s_add_u32 s48, s48, 4096
    buffer_store_dwordx4 v[80:83], v1, s[32:35], s48 offen offset:0 sc1
    buffer_store_dwordx4 v[84:87], v1, s[32:35], s48 offen offset:1024 sc1
    buffer_store_dwordx4 v[88:91], v1, s[32:35], s48 offen offset:2048 sc1
    buffer_store_dwordx4 v[92:95], v1, s[32:35], s48 offen offset:3072 sc1
    s_add_u32 s48, s48, 4096
    buffer_store_dwordx4 v[96:99], v1, s[32:35], s48 offen offset:0 sc1
    buffer_store_dwordx4 v[100:103], v1, s[32:35], s48 offen offset:1024 sc1
    buffer_store_dwordx4 v[104:107], v1, s[32:35], s48 offen offset:2048 sc1
    buffer_store_dwordx4 v[108:111], v1, s[32:35], s48 offen offset:3072 sc1
    s_add_u32 s48, s48, 4096
    buffer_store_dwordx4 v[112:115], v1, s[32:35], s48 offen offset:0 sc1
    s_lshl1_add_u32 s44, s41, s51
    s_mov_b32 s28, 0
    v_mov_b64 v[240:241], 0
    v_mov_b64 v[242:243], 0
    v_mov_b64 v[244:245], 0
    v_mov_b64 v[246:247], 0
    s_waitcnt lgkmcnt(0)
    s_cmp_lg_u64 s[78:79], 0
    s_cbranch_scc1 L_gn3_done
    v_mov_b32 v170, 0
    s_mov_b32 s72, 0x4000
L_gn3:
    global_load_dwordx2 v[172:173], v170, s[18:19] sc1
    s_sub_u32 s72, s72, 1
    s_waitcnt vmcnt(0)
    v_readfirstlane_b32 s78, v172
    v_readfirstlane_b32 s79, v173
    s_cmp_eq_u32 s72, 0
    s_cbranch_scc1 L_gn3_done
    s_sleep 8
    s_cmp_eq_u64 s[78:79], 0
    s_cbranch_scc1 L_gn3
L_gn3_done:
    s_waitcnt vmcnt(0)
    s_barrier
    s_cmp_lg_u32 s40, 0
    s_cbranch_scc1 L_wt1
    v_mul_u32_u24 v170, 33024, v0
    v_mov_b64 v[172:173], s[78:79]
    s_lshr_b32 s48, s44, 1
    s_lshl3_add_u32 s48, s43, s48
    s_and_b32 s49, s44, 1
    s_lshl4_add_u32 s49, s48, s49
    s_lshl3_add_u32 s49, s49, 26230784
    s_mov_b32 exec_hi, 0
    buffer_store_dwordx2 v[172:173], v170, s[32:35], s49 offen sc1
    s_mov_b32 exec_hi, -1
L_wt1:
    s_lshl_b32 s56, s46, 3
    s_add_u32 s56, s56, s40
    v_lshlrev_b32 v1, 4, v0
    s_mul_i32 s60, s45, 81920
    s_lshr_b32 s48, s56, 1
    v_and_b32 v23, 0x1f0, v1
    s_mul_i32 s48, s48, 2560
    s_add_u32 s60, s60, s48
    s_add_u32 s60, s60, 5242880
    s_mov_b32 s64, -1
    s_mov_b32 s65, 0
    s_mov_b32 s66, 0
    s_mov_b32 s67, -1
    s_mov_b32 s68, 0xfffff
    s_mov_b32 s69, 0xfffff
    s_mov_b32 s70, 0xff800000
    s_mov_b32 s71, 0xff800000
    s_cmp_ge_u32 s40, 4
    s_mov_b32 s62, 0xc4
    s_cselect_b32 s62, 125, s62
    s_cselect_b32 s57, 7, 64
    s_cselect_b32 s58, 4, 6
    s_or_b32 s62, s62, s28
    v_lshrrev_b32 v17, 5, v0
    v_mov_b32 v2, v1
    v_lshl_add_u32 v3, v17, 3, v23
    v_add_u32 v3, 2048, v3
    v_and_b32 v16, 31, v0
    v_lshrrev_b32 v18, 3, v16
    v_xor_b32 v18, v18, v17
    v_and_b32 v18, 1, v18
    v_lshlrev_b32 v18, 6, v18
    v_and_b32 v19, 3, v16
    v_lshl_add_u32 v18, v19, 4, v18
    v_lshrrev_b32 v19, 2, v16
    v_lshl_add_u32 v4, v19, 7, v18
    v_add_u32 v4, 2560, v4
    v_mov_b64 v[16:17], 0
    s_mov_b32 exec_lo, 0x11000000
    s_mov_b32 exec_hi, 0x11000000
    v_mov_b32 v16, 0x3f803f80
    v_mov_b32 v17, 0x3f803f80
    s_mov_b64 exec, -1
    v_mov_b64 v[28:29], 0
    v_mov_b64 v[30:31], 0
    v_mov_b64 v[42:43], 0
    s_mov_b64 exec, s[64:65]
    v_mov_b32 v42, 0x3f80
    s_mov_b64 exec, -1
    v_bfe_u32 v18, v0, 4, 1
    v_mul_u32_u24 v18, 20480, v18
    v_and_b32 v19, 15, v0
    s_mul_i32 s48, s56, 40960
    v_lshl_add_u32 v18, v19, 4, v18
    v_lshrrev_b32 v19, 5, v0
    s_lshl_b32 s49, s45, 9
    s_add_u32 s49, s49, s48
    v_lshl_add_u32 v14, v19, 8, v18
    v_add_u32 v14, s49, v14
    s_lshr_b32 s49, s45, 3
    s_lshl_b32 s49, s49, 10
    s_add_u32 s48, s48, s49
    s_and_b32 s49, s45, 3
    s_lshl_b32 s49, s49, 8
    s_add_u32 s48, s48, s49
    s_and_b32 s49, s45, 4
    s_lshl_b32 s49, s49, 1
    s_add_u32 s48, s48, s49
    s_add_u32 s48, s48, 16384
    v_add_u32 v15, s48, v18
    s_lshl_b32 s55, s40, 10
    s_add_u32 s55, s55, 65536
    s_mov_b32 s59, 20480
    s_lshr_b32 s48, s56, 1
    s_lshl_b32 s48, s48, 9
    s_lshl_b32 s49, s45, 4
    s_add_u32 s48, s48, s49
    s_and_b32 s49, s56, 1
    s_lshl_b32 s49, s49, 3
    s_add_u32 s48, s48, s49
    s_add_u32 s22, s48, 25231360
    v_mov_b64 v[136:137], v[16:17]
    v_mov_b64 v[138:139], v[16:17]
    v_mov_b64 v[140:141], v[16:17]
    v_mov_b64 v[142:143], v[16:17]
    v_mov_b64 v[144:145], v[16:17]
    v_mov_b64 v[146:147], v[16:17]
    v_mov_b64 v[148:149], v[16:17]
    v_mov_b64 v[150:151], v[16:17]
    v_mov_b64 v[152:153], v[16:17]
    v_mov_b64 v[154:155], v[16:17]
    v_mov_b64 v[156:157], v[16:17]
    v_mov_b64 v[158:159], v[16:17]
    v_mov_b64 v[160:161], v[16:17]
    v_mov_b64 v[162:163], v[16:17]
    v_mov_b64 v[164:165], v[16:17]
    v_mov_b64 v[166:167], v[16:17]
    v_mov_b64 v[168:169], 0
    v_mov_b32 v170, 0
    s_barrier
    s_and_b32 s50, s56, 1
    s_lshl_b32 s48, s50, 10
    s_add_u32 s48, s48, s60
    s_lshl_b32 s49, s50, 3
    s_add_u32 s49, s49, s60
    buffer_load_dwordx4 v[24:27], v1, s[32:35], s48 offen sc1
    buffer_load_dwordx2 v[20:21], v23, s[32:35], s49 offen offset:2048 sc1
    s_barrier
    s_waitcnt vmcnt(0)
    s_branch L_attn
L_cend:
L_fallback:
    s_waitcnt vmcnt(0) lgkmcnt(0)
    s_cmp_eq_u32 s58, 1
    s_cselect_b32 s51, 8388608, 0
    s_cselect_b32 s75, 256, -1
    s_cselect_b32 s74, s56, 63
    s_cselect_b32 s73, s56, 0
    s_cselect_b32 s52, 0, 4096
    s_max_u32 s73, s73, 8
    s_sub_u32 s73, s73, 8
    s_and_b32 s50, s56, 1
    s_lshl_b32 s48, s50, 10
    s_add_u32 s48, s48, s60
    s_lshl_b32 s49, s50, 3
    s_add_u32 s49, s49, s60
    s_add_u32 s48, s48, s51
    s_add_u32 s49, s49, s51
    s_add_u32 s51, s51, s63
    v_mov_b64 v[72:73], 0
    buffer_load_dwordx4 v[68:71], v1, s[32:35], s48 offen sc1
    s_mov_b64 exec, s[64:65]
    buffer_load_dwordx2 v[72:73], v23, s[32:35], s49 offen offset:2048 sc1
    s_mov_b64 exec, -1
    v_lshrrev_b32 v19, 5, v0
    v_and_b32 v18, 31, v0
    v_lshrrev_b32 v21, 3, v18
    v_xor_b32 v21, v21, v19
    v_and_b32 v21, 1, v21
    v_lshlrev_b32 v21, 6, v21
    v_and_b32 v22, 3, v18
    v_lshl_add_u32 v21, v22, 4, v21
    v_lshrrev_b32 v22, 2, v18
    v_lshl_add_u32 v20, v22, 7, v21
    v_lshlrev_b32 v19, 2, v19
    v_sub_u32 v18, v18, v19
    s_lshl_b32 s48, s56, 5
    s_add_u32 s48, s48, s52
    v_add_u32 v18, s48, v18
    v_mov_b32 v17, s70
    v_mov_b32 v22, s70
    v_mov_b64 v[84:85], 0
    v_mov_b64 v[86:87], 0
    v_mov_b64 v[88:89], 0
    v_mov_b64 v[90:91], 0
    v_mov_b64 v[92:93], 0
    v_mov_b64 v[94:95], 0
    v_mov_b64 v[96:97], 0
    v_mov_b64 v[98:99], 0
    s_mov_b32 s76, 0
L_fb_pass:
    s_mov_b32 s53, s73
L_fb_loop:
    s_lshr_b32 s48, s53, 1
    s_mul_i32 s48, s48, 5120
    s_add_u32 s48, s48, s51
    s_and_b32 s52, s53, 1
    s_lshl_b32 s49, s52, 10
    s_add_u32 s49, s49, s48
    buffer_load_dwordx4 v[116:119], v1, s[32:35], s49 offen sc1
    s_lshl_b32 s49, s52, 3
    s_add_u32 s49, s49, s48
    buffer_load_dwordx2 v[124:125], v23, s[32:35], s49 offen offset:2048 sc1
    s_mul_i32 s49, s52, 1280
    s_add_u32 s49, s49, s48
    s_mov_b64 exec, s[68:69]
    buffer_load_dwordx4 v[136:139], v20, s[32:35], s49 offen offset:2560 sc1
    buffer_load_dwordx4 v[140:143], v20, s[32:35], s49 offen offset:3200 sc1
    s_mov_b64 exec, -1
    s_lshl_b32 s48, s53, 5
    v_subrev_u32 v19, s48, v18
    s_waitcnt vmcnt(0)
    v_mfma_f32_32x32x8_bf16 v[52:67], v[124:125], v[72:73], 0
    v_mfma_f32_32x32x16_bf16 v[52:67], v[116:119], v[68:71], v[52:67]
    s_nop 7
    s_nop 3
    v_subrev_u32 v21, 0, v19
    v_cmp_gt_u32 vcc, s75, v21
    s_nop 1
    v_cndmask_b32 v52, v22, v52, vcc
    v_subrev_u32 v21, 1, v19
    v_cmp_gt_u32 vcc, s75, v21
    s_nop 1
    v_cndmask_b32 v53, v22, v53, vcc
    v_subrev_u32 v21, 2, v19
    v_cmp_gt_u32 vcc, s75, v21
    s_nop 1
    v_cndmask_b32 v54, v22, v54, vcc
    v_subrev_u32 v21, 3, v19
    v_cmp_gt_u32 vcc, s75, v21
    s_nop 1
    v_cndmask_b32 v55, v22, v55, vcc
    v_subrev_u32 v21, 8, v19
    v_cmp_gt_u32 vcc, s75, v21
    s_nop 1
    v_cndmask_b32 v56, v22, v56, vcc
    v_subrev_u32 v21, 9, v19
    v_cmp_gt_u32 vcc, s75, v21
    s_nop 1
    v_cndmask_b32 v57, v22, v57, vcc
    v_subrev_u32 v21, 10, v19
    v_cmp_gt_u32 vcc, s75, v21
    s_nop 1
    v_cndmask_b32 v58, v22, v58, vcc
    v_subrev_u32 v21, 11, v19
    v_cmp_gt_u32 vcc, s75, v21
    s_nop 1
    v_cndmask_b32 v59, v22, v59, vcc
    v_subrev_u32 v21, 16, v19
    v_cmp_gt_u32 vcc, s75, v21
    s_nop 1
    v_cndmask_b32 v60, v22, v60, vcc
    v_subrev_u32 v21, 17, v19
    v_cmp_gt_u32 vcc, s75, v21
    s_nop 1
    v_cndmask_b32 v61, v22, v61, vcc
    v_subrev_u32 v21, 18, v19
    v_cmp_gt_u32 vcc, s75, v21
    s_nop 1
    v_cndmask_b32 v62, v22, v62, vcc
    v_subrev_u32 v21, 19, v19
    v_cmp_gt_u32 vcc, s75, v21
    s_nop 1
    v_cndmask_b32 v63, v22, v63, vcc
    v_subrev_u32 v21, 24, v19
    v_cmp_gt_u32 vcc, s75, v21
    s_nop 1
    v_cndmask_b32 v64, v22, v64, vcc
    v_subrev_u32 v21, 25, v19
    v_cmp_gt_u32 vcc, s75, v21
    s_nop 1
    v_cndmask_b32 v65, v22, v65, vcc
    v_subrev_u32 v21, 26, v19
    v_cmp_gt_u32 vcc, s75, v21
    s_nop 1
    v_cndmask_b32 v66, v22, v66, vcc
    v_subrev_u32 v21, 27, v19
    v_cmp_gt_u32 vcc, s75, v21
    s_nop 1
    v_cndmask_b32 v67, v22, v67, vcc
    s_cmp_eq_u32 s76, 1
    s_cbranch_scc1 L_fb_p1
    v_max3_f32 v17, v17, v52, v53
    v_max3_f32 v17, v17, v54, v55
    v_max3_f32 v17, v17, v56, v57
    v_max3_f32 v17, v17, v58, v59
    v_max3_f32 v17, v17, v60, v61
    v_max3_f32 v17, v17, v62, v63
    v_max3_f32 v17, v17, v64, v65
    v_max3_f32 v17, v17, v66, v67
    s_branch L_fb_next
L_fb_p1:
    v_sub_f32 v52, v52, v17
    v_sub_f32 v53, v53, v17
    v_sub_f32 v54, v54, v17
    v_sub_f32 v55, v55, v17
    v_sub_f32 v56, v56, v17
    v_sub_f32 v57, v57, v17
    v_sub_f32 v58, v58, v17
    v_sub_f32 v59, v59, v17
    v_sub_f32 v60, v60, v17
    v_sub_f32 v61, v61, v17
    v_sub_f32 v62, v62, v17
    v_sub_f32 v63, v63, v17
    v_sub_f32 v64, v64, v17
    v_sub_f32 v65, v65, v17
    v_sub_f32 v66, v66, v17
    v_sub_f32 v67, v67, v17
    v_exp_f32 v52, v52
    v_exp_f32 v53, v53
    v_exp_f32 v54, v54
    v_exp_f32 v55, v55
    v_exp_f32 v56, v56
    v_exp_f32 v57, v57
    v_exp_f32 v58, v58
    v_exp_f32 v59, v59
    v_exp_f32 v60, v60
    v_exp_f32 v61, v61
    v_exp_f32 v62, v62
    v_exp_f32 v63, v63
    v_exp_f32 v64, v64
    v_exp_f32 v65, v65
    v_exp_f32 v66, v66
    v_exp_f32 v67, v67
    s_nop 0
    v_cvt_pk_bf16_f32 v44, v52, v53
    v_cvt_pk_bf16_f32 v45, v54, v55
    v_cvt_pk_bf16_f32 v46, v56, v57
    v_cvt_pk_bf16_f32 v47, v58, v59
    v_cvt_pk_bf16_f32 v48, v60, v61
    v_cvt_pk_bf16_f32 v49, v62, v63
    v_cvt_pk_bf16_f32 v50, v64, v65
    v_cvt_pk_bf16_f32 v51, v66, v67
    s_nop 1
    v_mfma_f32_32x32x16_bf16 v[84:99], v[136:139], v[44:47], v[84:99]
    v_mfma_f32_32x32x16_bf16 v[84:99], v[140:143], v[48:51], v[84:99]
    s_nop 7
    s_nop 3
L_fb_next:
    s_add_u32 s53, s53, 1
    s_cmp_le_u32 s53, s74
    s_cbranch_scc1 L_fb_loop
    s_cmp_eq_u32 s76, 1
    s_cbranch_scc1 L_fb_done
    v_mov_b32 v21, v17
    s_nop 1
    v_permlane32_swap_b32 v17, v21
    s_nop 1
    v_max_f32 v17, v17, v21
    s_mov_b32 s76, 1
    s_branch L_fb_pass
L_fb_done:
    v_rcp_f32 v16, v96
    s_cmp_eq_u32 s58, 1
    s_cbranch_scc1 L_fin1
    s_branch L_fin0
.section .rodata,"a"
.p2align 6
.amdhsa_kernel concat_heads__softmax_full_mha__sliding_block__prompt_kernel
  .amdhsa_next_free_vgpr 256
  .amdhsa_next_free_sgpr 102
  .amdhsa_accum_offset 256
  .amdhsa_group_segment_fixed_size 0
  .amdhsa_kernarg_size 72
  .amdhsa_user_sgpr_count 2
  .amdhsa_user_sgpr_kernarg_segment_ptr 1
  .amdhsa_system_sgpr_workgroup_id_x 1
.end_amdhsa_kernel
```
